```python
import torch

def _softmax(x, axis=-1):
    return torch.softmax(x, dim=axis)

def _gelu(x):
    return torch.nn.functional.gelu(x, approximate='tanh')

def _silu(x):
    return torch.nn.functional.silu(x)

def _sigmoid(x):
    return torch.sigmoid(x)

def _layernorm(x, axis=-1, eps=1e-05):
    m = x.mean(dim=axis, keepdim=True)
    v = x.var(dim=axis, keepdim=True, unbiased=False)
    return (x - m) / torch.sqrt(v + eps)

def _scatter_add(tgt, idx, src, axis=0):
    return tgt.clone().index_add_(axis, idx, src)

def _segment_sum(src, seg, n):
    out = torch.zeros((n,) + src.shape[1:], dtype=src.dtype)
    return out.index_add_(0, seg, src)

def _pad(x, pw):
    flat = tuple((v for pair in reversed(pw) for v in pair))
    return torch.nn.functional.pad(x, flat)
kernel_name = 'adaLN_cond__sliding_block_cached__glu_gated_reglu__decode'

def setup_inputs():

    _w = lambda a: (lambda t: t.to(torch.bfloat16) if t.is_floating_point() else t)(torch.as_tensor(a))

    def _A_setup():
        B, Sq, D = (8, 1, 640)
        Hq, Hkv, Sk, Dh = (32, 32, 4096, 128)
        assert Hq % Hkv == 0, (Hq, Hkv)
        return {'x': _w((lambda *s: torch.randn(*s, dtype=torch.bfloat16) * 0.05)(B, Sq, D)), 'k_cache': _w((lambda *s: torch.randn(*s, dtype=torch.bfloat16) * 3.2)(B, Hkv, Sk, Dh)), 'v_cache': _w((lambda *s: torch.randn(*s, dtype=torch.bfloat16) * 3.2)(B, Hkv, Sk, Dh)), 'wq': _w((lambda *s: torch.randn(*s, dtype=torch.bfloat16) * 3.2)(D, Hq * Dh) * D ** (-0.5)), 'wo': _w((lambda *s: torch.randn(*s, dtype=torch.bfloat16) * 3.2)(Hq * Dh, D) * (Hq * Dh) ** (-0.5))}
    _A_in = _A_setup()

    def _B_setup():
        B, S, D, F = (8, 1, 640, 1728)
        return {'x': _w((lambda *s: torch.randn(*s, dtype=torch.bfloat16) * 0.05)(B, S, D)), 'W_gate': _w((lambda *s: torch.randn(*s, dtype=torch.bfloat16) * 1.6)(D, F) * (2.0 / D) ** 0.5), 'W_up': _w((lambda *s: torch.randn(*s, dtype=torch.bfloat16) * 1.6)(D, F) * (2.0 / D) ** 0.5), 'W_down': _w((lambda *s: torch.randn(*s, dtype=torch.bfloat16) * 1.6)(F, D) * (1.0 / F) ** 0.5)}
    _B_in = _B_setup()
    return {'A_x': _A_in['x'], 'A_k_cache': _A_in['k_cache'], 'A_v_cache': _A_in['v_cache'], 'A_wq': _A_in['wq'], 'A_wo': _A_in['wo'], 'B_x': _B_in['x'], 'B_W_gate': _B_in['W_gate'], 'B_W_up': _B_in['W_up'], 'B_W_down': _B_in['W_down'], 'c': _w((lambda *s: torch.randn(*s, dtype=torch.bfloat16) * 0.2)(8, 640) * 8.0), 'w_mod': _w((lambda *s: torch.randn(*s, dtype=torch.bfloat16) * 0.2)(640, 6 * 640) * 640 ** (-0.5) * 8.0)}

def reference(A_x, A_k_cache, A_v_cache, A_wq, A_wo, B_x, B_W_gate, B_W_up, B_W_down, c, w_mod):

    def _A_ref(x, k_cache, v_cache, wq, wo):
        B, Sq, D = x.shape
        Hq, Dh = (32, 128)
        Hkv, Sk = (k_cache.shape[1], k_cache.shape[2])
        W = min(4096, max(256, Sk // 4))
        rep = Hq // Hkv
        q = (lambda x, *d: x.permute(*d))((x @ wq).reshape(B, Sq, Hq, Dh), 0, 2, 1, 3)
        k = (lambda x, n, axis: torch.repeat_interleave(x, n, dim=axis))(k_cache[:, :, Sk - W:, :], rep, axis=1)
        v = (lambda x, n, axis: torch.repeat_interleave(x, n, dim=axis))(v_cache[:, :, Sk - W:, :], rep, axis=1)
        scores = torch.einsum('bhqd,bhkd->bhqk', q, k) * Dh ** (-0.5)
        p = _softmax(scores, axis=-1)
        o = torch.einsum('bhqk,bhkd->bhqd', p, v)
        return (lambda x, *d: x.permute(*d))(o, 0, 2, 1, 3).reshape(B, Sq, Hq * Dh) @ wo

    def _B_ref(x, W_gate, W_up, W_down):
        gate = torch.einsum('bsd,df->bsf', x, W_gate)
        up = torch.einsum('bsd,df->bsf', x, W_up)
        gate = gate * (lambda x, dt: x.to(dt))(gate > 0, gate.dtype)
        h = gate * up
        return torch.einsum('bsf,fd->bsd', h, W_down)
    x = A_x
    mod = (_silu(c) @ w_mod).reshape(c.shape[0], 6, 1, -1)
    sa, ca, ga, sb, cb, gb = (mod[:, 0].clone(), mod[:, 1].clone(), mod[:, 2].clone(), mod[:, 3].clone(), mod[:, 4].clone(), mod[:, 5].clone())
    h = _layernorm(x, axis=-1) * (1 + ca) + sa
    x = x + ga * _A_ref(h, A_k_cache, A_v_cache, A_wq, A_wo)
    h = _layernorm(x, axis=-1) * (1 + cb) + sb
    x = x + gb * _B_ref(h, B_W_gate, B_W_up, B_W_down)
    return x
```

```asm
; @launch grid=(256,1,1) block=(1024,1,1) lds=162816
.amdgcn_target "amdgcn-amd-amdhsa--gfx950"
.text
.globl adaLN_cond__sliding_block_cached__glu_gated_reglu__decode_kernel
.p2align 8
.type adaLN_cond__sliding_block_cached__glu_gated_reglu__decode_kernel,@function
adaLN_cond__sliding_block_cached__glu_gated_reglu__decode_kernel:
    s_cmp_ge_u32 s2, 256
    s_cbranch_scc1 L_END
    s_load_dwordx8 s[20:27], s[0:1], 0
    s_load_dwordx2 s[28:29], s[0:1], 32
    s_load_dwordx4 s[32:35], s[0:1], 48
    s_load_dwordx8 s[36:43], s[0:1], 64
    s_load_dwordx2 s[8:9], s[0:1], 104
    v_lshrrev_b32 v8, 6, v0
    v_and_b32 v1, 63, v0
    v_readfirstlane_b32 s3, v8
    v_lshlrev_b32 v2, 4, v1
    s_and_b32 s6, s2, 7
    s_lshr_b32 s7, s2, 3
    s_lshr_b32 s16, s7, 3
    s_lshl_b32 s5, s6, 2
    s_add_u32 s5, s5, s16
    s_and_b32 s4, s7, 7
    s_lshl_b32 s12, s4, 5
    s_add_u32 s12, s12, s5
    s_lshl_b32 s12, s12, 20
    s_lshl_b32 s16, s3, 14
    s_add_u32 s12, s12, s16
    s_add_u32 s12, s12, 0xC0000
    s_mov_b32 s17, s12
    s_add_u32 s18, s7, s6
    s_add_u32 s16, s18, 0
    s_and_b32 s16, s16, 3
    s_lshl_b32 s16, s16, 12
    s_add_u32 s12, s17, s16
    s_add_u32 s16, s18, 1
    s_and_b32 s16, s16, 3
    s_lshl_b32 s16, s16, 12
    s_add_u32 s13, s17, s16
    s_add_u32 s16, s18, 2
    s_and_b32 s16, s16, 3
    s_lshl_b32 s16, s16, 12
    s_add_u32 s14, s17, s16
    s_add_u32 s16, s18, 3
    s_and_b32 s16, s16, 3
    s_lshl_b32 s16, s16, 12
    s_add_u32 s15, s17, s16
    v_and_b32 v0, 15, v1
    v_lshrrev_b32 v22, 4, v1
    s_mov_b32 s46, 268435456
    s_mov_b32 s47, 0x20000
    s_mov_b32 s50, 268435456
    s_mov_b32 s51, 0x20000
    s_mov_b32 s31, s3
    s_mul_i32 s30, s31, 6144
    s_add_u32 s30, s30, 23552
    v_lshlrev_b32 v14, 2, v1
    s_sub_u32 s16, s3, 0
    s_cmp_lt_u32 s16, 4
    s_cbranch_scc1 L_HELPER
    s_mov_b32 s99, 1
L_PH1:
    s_setprio 2
    v_lshlrev_b32 v10, 4, v0
    v_lshl_add_u32 v10, v22, 13, v10
    s_mul_i32 s18, s3, 327680
    s_lshl_b32 s19, s5, 8
    s_add_u32 s18, s18, s19
    s_waitcnt lgkmcnt(0)
    s_mov_b32 s44, s22
    s_and_b32 s45, s23, 0xffff
    buffer_load_dwordx4 v[24:27], v2, s[44:47], s12 offen offset:0 nt
    buffer_load_dwordx4 v[28:31], v2, s[44:47], s12 offen offset:1024 nt
    buffer_load_dwordx4 v[32:35], v2, s[44:47], s12 offen offset:2048 nt
    buffer_load_dwordx4 v[36:39], v2, s[44:47], s12 offen offset:3072 nt
    s_cmp_eq_u32 s99, 0
    s_cbranch_scc1 L_NOB0
    s_load_dwordx2 s[10:11], s[8:9], 0
    s_barrier
L_NOB0:
    s_cmp_eq_u32 s2, 248
    s_cbranch_scc0 L_NOCAL
    s_cmp_eq_u32 s3, 15
    s_cbranch_scc1 L_CAL
L_NOCAL:
    s_mov_b32 s60, s20
    s_and_b32 s61, s21, 0xffff
    s_mov_b32 s62, 0x2800
    s_mov_b32 s63, 0x20000
    s_mov_b32 s72, s26
    s_and_b32 s73, s27, 0xffff
    s_mov_b32 s74, 0x500000
    s_mov_b32 s75, 0x20000
    s_mov_b32 s52, s8
    s_and_b32 s53, s9, 0xffff
    s_mov_b32 s54, 0x1e0000
    s_mov_b32 s55, 0x20000
    v_lshl_add_u32 v15, v0, 2, v22
    v_lshlrev_b32 v13, 1, v15
    v_lshlrev_b32 v15, 2, v15
    s_mul_i32 s16, s4, 1280
    s_mul_i32 s17, s3, 80
    s_add_u32 s17, s17, s16
    buffer_load_dwordx4 v[16:19], v2, s[60:63], s16 offen
    buffer_load_dword v20, v14, s[60:63], s16 offen offset:1024
    buffer_load_ushort v21, v13, s[60:63], s17 offen
    s_mul_i32 s97, s4, 15360
    s_mul_i32 s17, s3, 160
    s_add_u32 s97, s97, s17
    s_add_u32 s97, s97, 65536
    buffer_load_dwordx4 v[40:43], v2, s[44:47], s13 offen offset:0 nt
    buffer_load_dwordx4 v[44:47], v2, s[44:47], s13 offen offset:1024 nt
    buffer_load_dwordx4 v[88:91], v10, s[72:75], s18 offen
    s_add_u32 s18, s18, 32768
    buffer_load_dwordx4 v[48:51], v2, s[44:47], s13 offen offset:2048 nt
    buffer_load_dwordx4 v[92:95], v10, s[72:75], s18 offen
    s_add_u32 s18, s18, 32768
    buffer_load_dwordx4 v[52:55], v2, s[44:47], s13 offen offset:3072 nt
    buffer_load_dwordx4 v[96:99], v10, s[72:75], s18 offen
    s_add_u32 s18, s18, 32768
    buffer_load_dwordx4 v[56:59], v2, s[44:47], s14 offen offset:0 nt
    buffer_load_dwordx4 v[100:103], v10, s[72:75], s18 offen
    s_add_u32 s18, s18, 32768
    buffer_load_dwordx4 v[60:63], v2, s[44:47], s14 offen offset:1024 nt
    buffer_load_dwordx4 v[104:107], v10, s[72:75], s18 offen
    s_add_u32 s18, s18, 32768
    buffer_load_dwordx4 v[64:67], v2, s[44:47], s14 offen offset:2048 nt
    buffer_load_dwordx4 v[108:111], v10, s[72:75], s18 offen
    s_add_u32 s18, s18, 32768
    buffer_load_dwordx4 v[68:71], v2, s[44:47], s14 offen offset:3072 nt
    buffer_load_dwordx4 v[112:115], v10, s[72:75], s18 offen
    s_add_u32 s18, s18, 32768
    buffer_load_dwordx4 v[72:75], v2, s[44:47], s15 offen offset:0 nt
    buffer_load_dwordx4 v[116:119], v10, s[72:75], s18 offen
    s_add_u32 s18, s18, 32768
    buffer_load_dwordx4 v[76:79], v2, s[44:47], s15 offen offset:1024 nt
    buffer_load_dwordx4 v[120:123], v10, s[72:75], s18 offen
    s_add_u32 s18, s18, 32768
    buffer_load_dwordx4 v[80:83], v2, s[44:47], s15 offen offset:2048 nt
    buffer_load_dwordx4 v[124:127], v10, s[72:75], s18 offen
    s_add_u32 s18, s18, 32768
    buffer_load_dwordx4 v[84:87], v2, s[44:47], s15 offen offset:3072 nt
    s_cmp_lt_u32 s3, 8
    s_cselect_b32 s19, 0x40000000, s97
    buffer_load_dword v11, v15, s[52:55], s19 offen sc1
    buffer_load_dword v12, v15, s[52:55], s19 offen offset:2560 sc1
    v_mov_b32 v8, 0
    v_mov_b32 v9, 1
    s_mov_b64 exec, 1
    ds_add_u32 v8, v9 offset:11600
    s_mov_b64 exec, -1
    s_setprio 1
    s_cmp_eq_u32 s99, 0
    s_cbranch_scc1 L_SETUP_DONE
    v_and_b32 v8, 1, v0
    v_lshlrev_b32 v8, 4, v8
    v_mov_b32 v9, 0xffff
    v_lshlrev_b32 v9, v8, v9
    v_bfe_u32 v8, v0, 1, 2
    v_cmp_eq_u32 vcc, 0, v8
    s_nop 1
    v_cndmask_b32 v3, 0, v9, vcc
    v_cmp_eq_u32 vcc, 1, v8
    s_nop 1
    v_cndmask_b32 v4, 0, v9, vcc
    v_cmp_eq_u32 vcc, 2, v8
    s_nop 1
    v_cndmask_b32 v5, 0, v9, vcc
    v_cmp_eq_u32 vcc, 3, v8
    s_nop 1
    v_cndmask_b32 v6, 0, v9, vcc
    s_mov_b32 s52, s8
    s_and_b32 s53, s9, 0xffff
    s_mov_b32 s54, 0x1e0000
    s_mov_b32 s55, 0x20000
    s_mov_b32 s84, 2097152
    s_waitcnt lgkmcnt(0)
    s_add_u32 s10, s10, 0x00010001
    s_addc_u32 s11, s11, 0x00010001
    s_and_b32 s76, s10, 0xffff
    s_lshr_b32 s77, s10, 16
    s_and_b32 s78, s11, 0xffff
    s_lshr_b32 s79, s11, 16
    s_and_b32 s80, s76, 0xf
    s_and_b32 s81, s77, 0xf
    s_and_b32 s82, s78, 0xf
    s_and_b32 s83, s79, 0xf
    v_mov_b32 v7, s10
    v_mov_b32 v10, s11
    v_cmp_lt_u32 vcc, 1, v22
    s_nop 1
    v_cndmask_b32 v7, v7, v10, vcc
    v_and_b32 v10, 1, v22
    v_lshlrev_b32 v10, 4, v10
    v_lshrrev_b32 v7, v10, v7
    v_and_b32 v7, 0xffff, v7
L_SETUP_DONE:
    s_waitcnt vmcnt(24)
    v_mov_b32 v8, 0
    v_lshlrev_b32 v9, 16, v16
    v_and_b32 v10, 0xffff0000, v16
    v_add_f32 v8, v8, v9
    v_add_f32 v8, v8, v10
    v_lshlrev_b32 v9, 16, v17
    v_and_b32 v10, 0xffff0000, v17
    v_add_f32 v8, v8, v9
    v_add_f32 v8, v8, v10
    v_lshlrev_b32 v9, 16, v18
    v_and_b32 v10, 0xffff0000, v18
    v_add_f32 v8, v8, v9
    v_add_f32 v8, v8, v10
    v_lshlrev_b32 v9, 16, v19
    v_and_b32 v10, 0xffff0000, v19
    v_add_f32 v8, v8, v9
    v_add_f32 v8, v8, v10
    v_lshlrev_b32 v9, 16, v20
    v_and_b32 v10, 0xffff0000, v20
    v_add_f32 v8, v8, v9
    v_add_f32 v8, v8, v10
    s_nop 1
    v_add_f32_dpp v8, v8, v8 row_ror:8 row_mask:0xf bank_mask:0xf
    s_nop 1
    v_add_f32_dpp v8, v8, v8 row_ror:4 row_mask:0xf bank_mask:0xf
    s_nop 1
    v_add_f32_dpp v8, v8, v8 row_ror:2 row_mask:0xf bank_mask:0xf
    s_nop 1
    v_add_f32_dpp v8, v8, v8 row_ror:1 row_mask:0xf bank_mask:0xf
    s_nop 1
    v_add_f32_dpp v8, v8, v8 row_bcast:15 row_mask:0xa bank_mask:0xf
    s_nop 1
    v_add_f32_dpp v8, v8, v8 row_bcast:31 row_mask:0xc bank_mask:0xf
    s_nop 0
    v_readlane_b32 s16, v8, 63
    s_nop 1
    v_mov_b32 v13, s16
    v_mul_f32 v13, 0x3acccccd, v13
    v_mov_b32 v8, 0
    v_lshlrev_b32 v9, 16, v16
    v_and_b32 v10, 0xffff0000, v16
    v_sub_f32 v9, v9, v13
    v_sub_f32 v10, v10, v13
    v_fmac_f32 v8, v9, v9
    v_fmac_f32 v8, v10, v10
    v_lshlrev_b32 v9, 16, v17
    v_and_b32 v10, 0xffff0000, v17
    v_sub_f32 v9, v9, v13
    v_sub_f32 v10, v10, v13
    v_fmac_f32 v8, v9, v9
    v_fmac_f32 v8, v10, v10
    v_lshlrev_b32 v9, 16, v18
    v_and_b32 v10, 0xffff0000, v18
    v_sub_f32 v9, v9, v13
    v_sub_f32 v10, v10, v13
    v_fmac_f32 v8, v9, v9
    v_fmac_f32 v8, v10, v10
    v_lshlrev_b32 v9, 16, v19
    v_and_b32 v10, 0xffff0000, v19
    v_sub_f32 v9, v9, v13
    v_sub_f32 v10, v10, v13
    v_fmac_f32 v8, v9, v9
    v_fmac_f32 v8, v10, v10
    v_lshlrev_b32 v9, 16, v20
    v_and_b32 v10, 0xffff0000, v20
    v_sub_f32 v9, v9, v13
    v_sub_f32 v10, v10, v13
    v_fmac_f32 v8, v9, v9
    v_fmac_f32 v8, v10, v10
    s_nop 1
    v_add_f32_dpp v8, v8, v8 row_ror:8 row_mask:0xf bank_mask:0xf
    s_nop 1
    v_add_f32_dpp v8, v8, v8 row_ror:4 row_mask:0xf bank_mask:0xf
    s_nop 1
    v_add_f32_dpp v8, v8, v8 row_ror:2 row_mask:0xf bank_mask:0xf
    s_nop 1
    v_add_f32_dpp v8, v8, v8 row_ror:1 row_mask:0xf bank_mask:0xf
    s_nop 1
    v_add_f32_dpp v8, v8, v8 row_bcast:15 row_mask:0xa bank_mask:0xf
    s_nop 1
    v_add_f32_dpp v8, v8, v8 row_bcast:31 row_mask:0xc bank_mask:0xf
    s_nop 0
    v_readlane_b32 s16, v8, 63
    s_nop 1
    v_mov_b32 v8, s16
    v_mul_f32 v8, 0x3acccccd, v8
    v_cvt_pk_bf16_f32 v8, v8, v8
    v_and_b32 v8, 0xffff0000, v8
    v_add_f32 v8, 0x3727c5ac, v8
    v_cvt_pk_bf16_f32 v8, v8, v8
    v_and_b32 v8, 0xffff0000, v8
    v_sqrt_f32 v8, v8
    s_nop 0
    v_cvt_pk_bf16_f32 v8, v8, v8
    v_and_b32 v8, 0xffff0000, v8
    v_rcp_f32 v8, v8
    v_cvt_pk_bf16_f32 v13, v13, v13
    v_and_b32 v13, 0xffff0000, v13
    v_lshlrev_b32 v21, 16, v21
    v_sub_f32 v21, v21, v13
    v_cvt_pk_bf16_f32 v21, v21, v21
    v_and_b32 v21, 0xffff0000, v21
    v_mul_f32 v21, v21, v8
    v_cvt_pk_bf16_f32 v21, v21, v21
    v_and_b32 v21, 0xffff0000, v21
    v_mov_b32 v13, 0xffff
    v_cmp_gt_u32 vcc, 10, v0
    s_nop 1
    v_cndmask_b32 v13, 0, v13, vcc
    s_waitcnt vmcnt(0)
    s_cmp_ge_u32 s3, 8
    s_cbranch_scc1 L_POLL1_IN
    v_mov_b32 v8, 0
    s_mov_b32 s17, 16777216
SP_1:
    ds_read_b32 v9, v8 offset:11600
    s_sub_u32 s17, s17, 1
    s_waitcnt lgkmcnt(0)
    v_readfirstlane_b32 s16, v9
    s_cmp_eq_u32 s17, 0
    s_cbranch_scc1 SPOK_2
    s_cmp_ge_u32 s16, 8
    s_cbranch_scc1 SPOK_2
    s_sleep 1
    s_branch SP_1
SPOK_2:
    s_branch L_POLL1_LD
L_POLL1:
    s_sleep 16
L_POLL1_LD:
    s_setprio 3
    buffer_load_dword v11, v15, s[52:55], s97 offen sc1
    buffer_load_dword v12, v15, s[52:55], s97 offen offset:2560 sc1
    s_waitcnt vmcnt(0)
L_POLL1_IN:
    v_xor_b32 v11, v11, v7
    v_xor_b32 v12, v12, v7
    v_or_b32 v8, v11, v12
    v_and_b32 v8, v8, v13
    v_cmp_ne_u32 vcc, 0, v8
    s_sub_u32 s84, s84, 1
    s_cmp_lt_i32 s84, 0
    s_cbranch_scc1 OK_3
    s_cbranch_vccnz L_POLL1
OK_3:
    v_add_f32 v12, 1.0, v12
    v_cvt_pk_bf16_f32 v12, v12, v12
    v_and_b32 v12, 0xffff0000, v12
    v_mul_f32 v12, v21, v12
    v_cvt_pk_bf16_f32 v12, v12, v12
    v_and_b32 v12, 0xffff0000, v12
    v_add_f32 v12, v12, v11
    v_cvt_pk_bf16_f32 v20, v12, v12
    s_nop 1
    v_and_b32_dpp v8, v20, v3 row_newbcast:0 row_mask:0xf bank_mask:0xf
    v_and_b32_dpp v9, v20, v4 row_newbcast:0 row_mask:0xf bank_mask:0xf
    v_and_b32_dpp v10, v20, v5 row_newbcast:0 row_mask:0xf bank_mask:0xf
    v_and_b32_dpp v11, v20, v6 row_newbcast:0 row_mask:0xf bank_mask:0xf
    s_nop 1
    v_mfma_f32_16x16x32_bf16 v[16:19], v[8:11], v[88:91], 0
    v_and_b32_dpp v12, v20, v3 row_newbcast:1 row_mask:0xf bank_mask:0xf
    v_and_b32_dpp v13, v20, v4 row_newbcast:1 row_mask:0xf bank_mask:0xf
    v_and_b32_dpp v14, v20, v5 row_newbcast:1 row_mask:0xf bank_mask:0xf
    v_and_b32_dpp v15, v20, v6 row_newbcast:1 row_mask:0xf bank_mask:0xf
    s_nop 1
    v_mfma_f32_16x16x32_bf16 v[16:19], v[12:15], v[92:95], v[16:19]
    v_and_b32_dpp v8, v20, v3 row_newbcast:2 row_mask:0xf bank_mask:0xf
    v_and_b32_dpp v9, v20, v4 row_newbcast:2 row_mask:0xf bank_mask:0xf
    v_and_b32_dpp v10, v20, v5 row_newbcast:2 row_mask:0xf bank_mask:0xf
    v_and_b32_dpp v11, v20, v6 row_newbcast:2 row_mask:0xf bank_mask:0xf
    s_nop 1
    v_mfma_f32_16x16x32_bf16 v[16:19], v[8:11], v[96:99], v[16:19]
    v_and_b32_dpp v12, v20, v3 row_newbcast:3 row_mask:0xf bank_mask:0xf
    v_and_b32_dpp v13, v20, v4 row_newbcast:3 row_mask:0xf bank_mask:0xf
    v_and_b32_dpp v14, v20, v5 row_newbcast:3 row_mask:0xf bank_mask:0xf
    v_and_b32_dpp v15, v20, v6 row_newbcast:3 row_mask:0xf bank_mask:0xf
    s_nop 1
    v_mfma_f32_16x16x32_bf16 v[16:19], v[12:15], v[100:103], v[16:19]
    v_and_b32_dpp v8, v20, v3 row_newbcast:4 row_mask:0xf bank_mask:0xf
    v_and_b32_dpp v9, v20, v4 row_newbcast:4 row_mask:0xf bank_mask:0xf
    v_and_b32_dpp v10, v20, v5 row_newbcast:4 row_mask:0xf bank_mask:0xf
    v_and_b32_dpp v11, v20, v6 row_newbcast:4 row_mask:0xf bank_mask:0xf
    s_nop 1
    v_mfma_f32_16x16x32_bf16 v[16:19], v[8:11], v[104:107], v[16:19]
    v_and_b32_dpp v12, v20, v3 row_newbcast:5 row_mask:0xf bank_mask:0xf
    v_and_b32_dpp v13, v20, v4 row_newbcast:5 row_mask:0xf bank_mask:0xf
    v_and_b32_dpp v14, v20, v5 row_newbcast:5 row_mask:0xf bank_mask:0xf
    v_and_b32_dpp v15, v20, v6 row_newbcast:5 row_mask:0xf bank_mask:0xf
    s_nop 1
    v_mfma_f32_16x16x32_bf16 v[16:19], v[12:15], v[108:111], v[16:19]
    v_and_b32_dpp v8, v20, v3 row_newbcast:6 row_mask:0xf bank_mask:0xf
    v_and_b32_dpp v9, v20, v4 row_newbcast:6 row_mask:0xf bank_mask:0xf
    v_and_b32_dpp v10, v20, v5 row_newbcast:6 row_mask:0xf bank_mask:0xf
    v_and_b32_dpp v11, v20, v6 row_newbcast:6 row_mask:0xf bank_mask:0xf
    s_nop 1
    v_mfma_f32_16x16x32_bf16 v[16:19], v[8:11], v[112:115], v[16:19]
    v_and_b32_dpp v12, v20, v3 row_newbcast:7 row_mask:0xf bank_mask:0xf
    v_and_b32_dpp v13, v20, v4 row_newbcast:7 row_mask:0xf bank_mask:0xf
    v_and_b32_dpp v14, v20, v5 row_newbcast:7 row_mask:0xf bank_mask:0xf
    v_and_b32_dpp v15, v20, v6 row_newbcast:7 row_mask:0xf bank_mask:0xf
    s_nop 1
    v_mfma_f32_16x16x32_bf16 v[16:19], v[12:15], v[116:119], v[16:19]
    v_and_b32_dpp v8, v20, v3 row_newbcast:8 row_mask:0xf bank_mask:0xf
    v_and_b32_dpp v9, v20, v4 row_newbcast:8 row_mask:0xf bank_mask:0xf
    v_and_b32_dpp v10, v20, v5 row_newbcast:8 row_mask:0xf bank_mask:0xf
    v_and_b32_dpp v11, v20, v6 row_newbcast:8 row_mask:0xf bank_mask:0xf
    s_nop 1
    v_mfma_f32_16x16x32_bf16 v[16:19], v[8:11], v[120:123], v[16:19]
    v_and_b32_dpp v12, v20, v3 row_newbcast:9 row_mask:0xf bank_mask:0xf
    v_and_b32_dpp v13, v20, v4 row_newbcast:9 row_mask:0xf bank_mask:0xf
    v_and_b32_dpp v14, v20, v5 row_newbcast:9 row_mask:0xf bank_mask:0xf
    v_and_b32_dpp v15, v20, v6 row_newbcast:9 row_mask:0xf bank_mask:0xf
    s_nop 1
    v_mfma_f32_16x16x32_bf16 v[16:19], v[12:15], v[124:127], v[16:19]
    s_mul_i32 s16, s3, 528
    v_lshlrev_b32 v8, 5, v0
    v_lshl_add_u32 v8, v22, 4, v8
    v_add_u32 v8, s16, v8
    s_mov_b32 exec_hi, 0
    s_nop 3
    ds_write_b128 v8, v[16:19] offset:0
    s_mov_b32 exec_hi, -1
    v_mov_b32 v10, 0
    v_mov_b32 v11, 1
    s_waitcnt lgkmcnt(0)
    s_mov_b64 exec, 1
    ds_add_rtn_u32 v11, v10, v11 offset:11592
    s_mov_b64 exec, -1
    s_waitcnt lgkmcnt(0)
    v_readfirstlane_b32 s16, v11
    s_nop 3
    s_cmp_lg_u32 s16, 15
    s_cbranch_scc1 L_QDONE
    v_and_b32 v8, 31, v1
    v_lshrrev_b32 v9, 5, v1
    v_mul_u32_u24 v10, 4224, v9
    v_lshl_add_u32 v10, v8, 4, v10
    ds_read_b128 v[88:91], v10 offset:0
    ds_read_b128 v[92:95], v10 offset:528
    ds_read_b128 v[96:99], v10 offset:1056
    ds_read_b128 v[100:103], v10 offset:1584
    ds_read_b128 v[104:107], v10 offset:2112
    ds_read_b128 v[108:111], v10 offset:2640
    ds_read_b128 v[112:115], v10 offset:3168
    ds_read_b128 v[116:119], v10 offset:3696
    v_lshlrev_b32 v8, 3, v8
    v_lshl_add_u32 v8, v9, 2, v8
    s_waitcnt lgkmcnt(6)
    v_add_f32 v88, v88, v92
    v_add_f32 v89, v89, v93
    v_add_f32 v90, v90, v94
    v_add_f32 v91, v91, v95
    s_waitcnt lgkmcnt(5)
    v_add_f32 v88, v88, v96
    v_add_f32 v89, v89, v97
    v_add_f32 v90, v90, v98
    v_add_f32 v91, v91, v99
    s_waitcnt lgkmcnt(4)
    v_add_f32 v88, v88, v100
    v_add_f32 v89, v89, v101
    v_add_f32 v90, v90, v102
    v_add_f32 v91, v91, v103
    s_waitcnt lgkmcnt(3)
    v_add_f32 v88, v88, v104
    v_add_f32 v89, v89, v105
    v_add_f32 v90, v90, v106
    v_add_f32 v91, v91, v107
    s_waitcnt lgkmcnt(2)
    v_add_f32 v88, v88, v108
    v_add_f32 v89, v89, v109
    v_add_f32 v90, v90, v110
    v_add_f32 v91, v91, v111
    s_waitcnt lgkmcnt(1)
    v_add_f32 v88, v88, v112
    v_add_f32 v89, v89, v113
    v_add_f32 v90, v90, v114
    v_add_f32 v91, v91, v115
    s_waitcnt lgkmcnt(0)
    v_add_f32 v88, v88, v116
    v_add_f32 v89, v89, v117
    v_add_f32 v90, v90, v118
    v_add_f32 v91, v91, v119
    s_nop 1
    v_permlane32_swap_b32 v88, v90
    v_permlane32_swap_b32 v89, v91
    s_nop 0
    v_add_f32 v88, v88, v90
    v_add_f32 v89, v89, v91
    v_cvt_pk_bf16_f32 v88, v88, v89
    ds_write_b32 v8, v88 offset:10560
    v_mov_b32 v10, 0
    v_mov_b32 v11, 1
    s_waitcnt lgkmcnt(0)
    ds_write_b32 v10, v11 offset:11596
    s_waitcnt lgkmcnt(0)
L_QDONE:
    s_cmp_lt_u32 s3, 8
    s_cbranch_scc1 L_PH2
    s_waitcnt vmcnt(0)
    s_branch L_QKS
L_PH2:
    v_mov_b32 v8, 0
    s_mov_b32 s17, 16777216
SP_4:
    ds_read_b32 v9, v8 offset:11600
    s_sub_u32 s17, s17, 1
    s_waitcnt lgkmcnt(0)
    v_readfirstlane_b32 s16, v9
    s_cmp_eq_u32 s17, 0
    s_cbranch_scc1 SPOK_5
    s_cmp_ge_u32 s16, 16
    s_cbranch_scc1 SPOK_5
    s_sleep 1
    s_branch SP_4
SPOK_5:
    s_setprio 0
    s_mov_b32 s48, s24
    s_and_b32 s49, s25, 0xffff
    s_add_u32 s16, s30, 0
    s_mov_b32 m0, s16
    s_nop 0
    buffer_load_dwordx4 v2, s[48:51], s12 offen offset:0 nt lds
    buffer_load_dwordx4 v2, s[48:51], s12 offen offset:1024 nt lds
    buffer_load_dwordx4 v2, s[48:51], s12 offen offset:2048 nt lds
    buffer_load_dwordx4 v2, s[48:51], s12 offen offset:3072 nt lds
    s_add_u32 s16, s30, 4096
    s_mov_b32 m0, s16
    s_nop 0
    buffer_load_dwordx4 v2, s[48:51], s13 offen offset:0 nt lds
    buffer_load_dwordx4 v2, s[48:51], s13 offen offset:1024 nt lds
    buffer_load_dwordx4 v[88:91], v2, s[48:51], s13 offen offset:2048 nt
    buffer_load_dwordx4 v[92:95], v2, s[48:51], s13 offen offset:3072 nt
    buffer_load_dwordx4 v[96:99], v2, s[48:51], s14 offen offset:0 nt
    buffer_load_dwordx4 v[100:103], v2, s[48:51], s14 offen offset:1024 nt
    buffer_load_dwordx4 v[104:107], v2, s[48:51], s14 offen offset:2048 nt
    buffer_load_dwordx4 v[108:111], v2, s[48:51], s14 offen offset:3072 nt
    buffer_load_dwordx4 v[112:115], v2, s[48:51], s15 offen offset:0 nt
    buffer_load_dwordx4 v[116:119], v2, s[48:51], s15 offen offset:1024 nt
    buffer_load_dwordx4 v[120:123], v2, s[48:51], s15 offen offset:2048 nt
    buffer_load_dwordx4 v[124:127], v2, s[48:51], s15 offen offset:3072 nt
    v_mov_b32 v8, 0
    v_mov_b32 v9, 1
    s_mov_b64 exec, 1
    ds_add_u32 v8, v9 offset:11604
    s_mov_b64 exec, -1
    s_setprio 1
    s_cmp_ge_u32 s3, 8
    s_cbranch_scc1 L_PV
L_QKS:
    v_mov_b32 v10, 0
    s_mov_b32 s17, 16777216
SP_6:
    ds_read_b32 v11, v10 offset:11596
    s_sub_u32 s17, s17, 1
    s_waitcnt lgkmcnt(0)
    v_readfirstlane_b32 s16, v11
    s_cmp_eq_u32 s17, 0
    s_cbranch_scc1 SPOK_7
    s_cmp_eq_u32 s16, 1
    s_cbranch_scc1 SPOK_7
    s_sleep 1
    s_branch SP_6
SPOK_7:
    v_lshlrev_b32 v8, 4, v0
    ds_read_b128 v[12:15], v8 offset:10560
    s_load_dword s99, s[8:9], 4096
    s_mov_b32 s87, 1
    s_mul_i32 s88, s6, 10
    s_add_u32 s88, s88, s7
    s_cmp_lt_u32 s7, 10
    s_cbranch_scc1 RID_8
    s_mov_b32 s87, 3
    s_mul_i32 s88, s6, 5
    s_add_u32 s88, s88, s7
    s_sub_u32 s88, s88, 10
    s_sub_u32 s16, s7, 10
    s_cmp_lt_u32 s16, 5
    s_cbranch_scc1 RID_8
    s_mov_b32 s87, 0
    s_cmp_lt_u32 s7, 23
    s_cbranch_scc1 RID_8
    s_cmp_ge_u32 s7, 30
    s_cbranch_scc1 RID_8
    s_mul_i32 s88, s6, 7
    s_add_u32 s88, s88, s7
    s_sub_u32 s88, s88, 23
    s_cmp_lt_u32 s88, 54
    s_cselect_b32 s87, 2, 0
RID_8:
    s_waitcnt vmcnt(16) lgkmcnt(0)
POL_9:
    s_xor_b32 s99, s99, s10
    s_lshr_b32 s16, s99, 1
    s_cbranch_scc0 POLOK_10
    s_sub_u32 s84, s84, 1
    s_cmp_lt_i32 s84, 0
    s_cbranch_scc1 POLOK_10
    s_sleep 32
    s_load_dword s99, s[8:9], 4096 glc
    s_waitcnt lgkmcnt(0)
    s_branch POL_9
POLOK_10:
    s_and_b32 s99, s99, 1
    s_lshr_b32 s98, s6, 2
    s_xor_b32 s98, s98, s99
    s_lshl_b32 s98, s98, 13
    s_and_b32 s16, s6, 1
    s_lshl_b32 s16, s16, 16
    s_add_u32 s98, s98, s16
    v_dot2_f32_bf16 v24, v24, v12, 0
    v_dot2_f32_bf16 v24, v25, v13, v24
    v_dot2_f32_bf16 v24, v26, v14, v24
    v_dot2_f32_bf16 v24, v27, v15, v24
    v_dot2_f32_bf16 v28, v28, v12, 0
    v_dot2_f32_bf16 v28, v29, v13, v28
    v_dot2_f32_bf16 v28, v30, v14, v28
    v_dot2_f32_bf16 v28, v31, v15, v28
    v_dot2_f32_bf16 v32, v32, v12, 0
    v_dot2_f32_bf16 v32, v33, v13, v32
    v_dot2_f32_bf16 v32, v34, v14, v32
    v_dot2_f32_bf16 v32, v35, v15, v32
    v_dot2_f32_bf16 v36, v36, v12, 0
    v_dot2_f32_bf16 v36, v37, v13, v36
    v_dot2_f32_bf16 v36, v38, v14, v36
    v_dot2_f32_bf16 v36, v39, v15, v36
    v_dot2_f32_bf16 v40, v40, v12, 0
    v_dot2_f32_bf16 v40, v41, v13, v40
    v_dot2_f32_bf16 v40, v42, v14, v40
    v_dot2_f32_bf16 v40, v43, v15, v40
    v_dot2_f32_bf16 v44, v44, v12, 0
    v_dot2_f32_bf16 v44, v45, v13, v44
    v_dot2_f32_bf16 v44, v46, v14, v44
    v_dot2_f32_bf16 v44, v47, v15, v44
    v_dot2_f32_bf16 v48, v48, v12, 0
    v_dot2_f32_bf16 v48, v49, v13, v48
    v_dot2_f32_bf16 v48, v50, v14, v48
    v_dot2_f32_bf16 v48, v51, v15, v48
    v_dot2_f32_bf16 v52, v52, v12, 0
    v_dot2_f32_bf16 v52, v53, v13, v52
    v_dot2_f32_bf16 v52, v54, v14, v52
    v_dot2_f32_bf16 v52, v55, v15, v52
    v_dot2_f32_bf16 v56, v56, v12, 0
    v_dot2_f32_bf16 v56, v57, v13, v56
    v_dot2_f32_bf16 v56, v58, v14, v56
    v_dot2_f32_bf16 v56, v59, v15, v56
    v_dot2_f32_bf16 v60, v60, v12, 0
    v_dot2_f32_bf16 v60, v61, v13, v60
    v_dot2_f32_bf16 v60, v62, v14, v60
    v_dot2_f32_bf16 v60, v63, v15, v60
    v_dot2_f32_bf16 v64, v64, v12, 0
    v_dot2_f32_bf16 v64, v65, v13, v64
    v_dot2_f32_bf16 v64, v66, v14, v64
    v_dot2_f32_bf16 v64, v67, v15, v64
    v_dot2_f32_bf16 v68, v68, v12, 0
    v_dot2_f32_bf16 v68, v69, v13, v68
    v_dot2_f32_bf16 v68, v70, v14, v68
    v_dot2_f32_bf16 v68, v71, v15, v68
    v_dot2_f32_bf16 v72, v72, v12, 0
    v_dot2_f32_bf16 v72, v73, v13, v72
    v_dot2_f32_bf16 v72, v74, v14, v72
    v_dot2_f32_bf16 v72, v75, v15, v72
    v_dot2_f32_bf16 v76, v76, v12, 0
    v_dot2_f32_bf16 v76, v77, v13, v76
    v_dot2_f32_bf16 v76, v78, v14, v76
    v_dot2_f32_bf16 v76, v79, v15, v76
    v_dot2_f32_bf16 v80, v80, v12, 0
    v_dot2_f32_bf16 v80, v81, v13, v80
    v_dot2_f32_bf16 v80, v82, v14, v80
    v_dot2_f32_bf16 v80, v83, v15, v80
    v_dot2_f32_bf16 v84, v84, v12, 0
    v_dot2_f32_bf16 v84, v85, v13, v84
    v_dot2_f32_bf16 v84, v86, v14, v84
    v_dot2_f32_bf16 v84, v87, v15, v84
    s_nop 2
    v_add_f32_dpp v24, v24, v24 row_ror:8 row_mask:0xf bank_mask:0x3
    v_add_f32_dpp v28, v28, v28 row_ror:8 row_mask:0xf bank_mask:0x3
    v_add_f32_dpp v32, v32, v32 row_ror:8 row_mask:0xf bank_mask:0x3
    v_add_f32_dpp v36, v36, v36 row_ror:8 row_mask:0xf bank_mask:0x3
    v_add_f32_dpp v40, v40, v40 row_ror:8 row_mask:0xf bank_mask:0x3
    v_add_f32_dpp v44, v44, v44 row_ror:8 row_mask:0xf bank_mask:0x3
    v_add_f32_dpp v48, v48, v48 row_ror:8 row_mask:0xf bank_mask:0x3
    v_add_f32_dpp v52, v52, v52 row_ror:8 row_mask:0xf bank_mask:0x3
    v_add_f32_dpp v24, v56, v56 row_ror:8 row_mask:0xf bank_mask:0xc
    v_add_f32_dpp v28, v60, v60 row_ror:8 row_mask:0xf bank_mask:0xc
    v_add_f32_dpp v32, v64, v64 row_ror:8 row_mask:0xf bank_mask:0xc
    v_add_f32_dpp v36, v68, v68 row_ror:8 row_mask:0xf bank_mask:0xc
    v_add_f32_dpp v40, v72, v72 row_ror:8 row_mask:0xf bank_mask:0xc
    v_add_f32_dpp v44, v76, v76 row_ror:8 row_mask:0xf bank_mask:0xc
    v_add_f32_dpp v48, v80, v80 row_ror:8 row_mask:0xf bank_mask:0xc
    v_add_f32_dpp v52, v84, v84 row_ror:8 row_mask:0xf bank_mask:0xc
    s_nop 1
    v_add_f32_dpp v24, v24, v24 row_half_mirror row_mask:0xf bank_mask:0x5
    v_add_f32_dpp v28, v28, v28 row_half_mirror row_mask:0xf bank_mask:0x5
    v_add_f32_dpp v32, v32, v32 row_half_mirror row_mask:0xf bank_mask:0x5
    v_add_f32_dpp v36, v36, v36 row_half_mirror row_mask:0xf bank_mask:0x5
    v_add_f32_dpp v24, v40, v40 row_half_mirror row_mask:0xf bank_mask:0xa
    v_add_f32_dpp v28, v44, v44 row_half_mirror row_mask:0xf bank_mask:0xa
    v_add_f32_dpp v32, v48, v48 row_half_mirror row_mask:0xf bank_mask:0xa
    v_add_f32_dpp v36, v52, v52 row_half_mirror row_mask:0xf bank_mask:0xa
    s_mov_b32 vcc_lo, 0xcccccccc
    s_mov_b32 vcc_hi, 0xcccccccc
    v_cndmask_b32 v8, v24, v32, vcc
    v_cndmask_b32 v9, v32, v24, vcc
    v_cndmask_b32 v10, v28, v36, vcc
    v_cndmask_b32 v11, v36, v28, vcc
    s_nop 1
    v_add_f32_dpp v8, v9, v8 quad_perm:[2,3,0,1] row_mask:0xf bank_mask:0xf
    v_add_f32_dpp v10, v11, v10 quad_perm:[2,3,0,1] row_mask:0xf bank_mask:0xf
    s_mov_b32 vcc_lo, 0xaaaaaaaa
    s_mov_b32 vcc_hi, 0xaaaaaaaa
    v_cndmask_b32 v21, v8, v10, vcc
    v_cndmask_b32 v9, v10, v8, vcc
    s_nop 1
    v_add_f32_dpp v21, v9, v21 quad_perm:[1,0,3,2] row_mask:0xf bank_mask:0xf
    v_cvt_pk_bf16_f32 v21, v21, v21
    v_and_b32 v21, 0xffff0000, v21
    v_mul_f32 v21, 0x3db504f3, v21
    v_cvt_pk_bf16_f32 v21, v21, v21
    v_and_b32 v21, 0xffff0000, v21
    v_max_f32 v8, 0xff7fffff, v21
    s_nop 1
    v_max_f32_dpp v8, v8, v8 row_ror:8 row_mask:0xf bank_mask:0xf
    s_nop 1
    v_max_f32_dpp v8, v8, v8 row_ror:4 row_mask:0xf bank_mask:0xf
    s_nop 1
    v_max_f32_dpp v8, v8, v8 row_ror:2 row_mask:0xf bank_mask:0xf
    s_nop 1
    v_max_f32_dpp v8, v8, v8 row_ror:1 row_mask:0xf bank_mask:0xf
    s_nop 1
    v_max_f32_dpp v8, v8, v8 row_bcast:15 row_mask:0xa bank_mask:0xf
    s_nop 1
    v_max_f32_dpp v8, v8, v8 row_bcast:31 row_mask:0xc bank_mask:0xf
    s_nop 0
    v_readlane_b32 s16, v8, 63
    s_nop 1
    v_subrev_f32 v21, s16, v21
    v_mul_f32 v21, 0x3fb8aa3b, v21
    v_exp_f32 v21, v21
    v_mov_b32 v10, s16
    v_mov_b32 v8, v21
    v_cvt_pk_bf16_f32 v20, v21, v21
    s_nop 1
    v_add_f32_dpp v8, v8, v8 row_ror:8 row_mask:0xf bank_mask:0xf
    s_nop 1
    v_add_f32_dpp v8, v8, v8 row_ror:4 row_mask:0xf bank_mask:0xf
    s_nop 1
    v_add_f32_dpp v8, v8, v8 row_ror:2 row_mask:0xf bank_mask:0xf
    s_nop 1
    v_add_f32_dpp v8, v8, v8 row_ror:1 row_mask:0xf bank_mask:0xf
    s_nop 1
    v_add_f32_dpp v8, v8, v8 row_bcast:15 row_mask:0xa bank_mask:0xf
    s_nop 1
    v_add_f32_dpp v8, v8, v8 row_bcast:31 row_mask:0xc bank_mask:0xf
    s_nop 0
    v_readlane_b32 s16, v8, 63
    s_nop 1
    v_mov_b32 v11, s16
    s_lshl_b32 s16, s3, 3
    v_mov_b32 v8, s16
    v_mov_b32 v9, 0
    s_mov_b64 exec, 1
    ds_write_b64 v8, v[10:11] offset:11648
    ds_max_f32 v9, v10 offset:11588
    v_mov_b32 v12, 1
    ds_add_u32 v9, v12 offset:11608
    s_mov_b64 exec, -1
    s_cmp_ge_u32 s3, 8
    s_cbranch_scc1 L_PH2
L_PV:
    v_add_u32 v21, s30, v2
    s_waitcnt vmcnt(10) lgkmcnt(0)
    ds_read_b128 v[48:51], v21 offset:0
    ds_read_b128 v[52:55], v21 offset:1024
    ds_read_b128 v[56:59], v21 offset:2048
    ds_read_b128 v[60:63], v21 offset:3072
    ds_read_b128 v[64:67], v21 offset:4096
    ds_read_b128 v[68:71], v21 offset:5120
    v_lshlrev_b32 v75, 5, v0
    v_lshl_add_u32 v75, v22, 4, v75
    s_mul_i32 s16, s3, 528
    v_add_u32 v75, s16, v75
    s_and_b32 s85, s4, 3
    s_mul_i32 s85, s85, 163840
    s_lshr_b32 s17, s4, 2
    s_xor_b32 s17, s17, s99
    s_lshl_b32 s17, s17, 13
    s_add_u32 s85, s85, s17
    s_lshl_b32 s17, s5, 7
    s_add_u32 s85, s85, s17
    s_sub_u32 s17, s31, 13
    s_lshl_b32 s16, s17, 16
    s_add_u32 s85, s85, s16
    s_add_u32 s85, s85, 524288
    s_lshl_b32 s17, s17, 10
    v_and_b32 v76, 7, v1
    v_lshlrev_b32 v76, 4, v76
    v_lshl_add_u32 v76, v22, 14, v76
    v_bfe_u32 v77, v1, 3, 1
    v_lshl_add_u32 v76, v77, 12, v76
    s_add_u32 s17, s17, 72704
    v_add_u32 v74, s17, v2
    v_and_b32_dpp v8, v20, v3 row_newbcast:0 row_mask:0xf bank_mask:0xf
    v_and_b32_dpp v9, v20, v4 row_newbcast:0 row_mask:0xf bank_mask:0xf
    v_and_b32_dpp v10, v20, v5 row_newbcast:0 row_mask:0xf bank_mask:0xf
    v_and_b32_dpp v11, v20, v6 row_newbcast:0 row_mask:0xf bank_mask:0xf
    s_nop 0
    s_waitcnt lgkmcnt(5)
    v_mfma_f32_16x16x32_bf16 v[16:19], v[8:11], v[48:51], 0
    v_and_b32_dpp v12, v20, v3 row_newbcast:1 row_mask:0xf bank_mask:0xf
    v_and_b32_dpp v13, v20, v4 row_newbcast:1 row_mask:0xf bank_mask:0xf
    v_and_b32_dpp v14, v20, v5 row_newbcast:1 row_mask:0xf bank_mask:0xf
    v_and_b32_dpp v15, v20, v6 row_newbcast:1 row_mask:0xf bank_mask:0xf
    s_nop 0
    s_waitcnt lgkmcnt(4)
    v_mfma_f32_16x16x32_bf16 v[16:19], v[12:15], v[52:55], v[16:19]
    v_and_b32_dpp v8, v20, v3 row_newbcast:2 row_mask:0xf bank_mask:0xf
    v_and_b32_dpp v9, v20, v4 row_newbcast:2 row_mask:0xf bank_mask:0xf
    v_and_b32_dpp v10, v20, v5 row_newbcast:2 row_mask:0xf bank_mask:0xf
    v_and_b32_dpp v11, v20, v6 row_newbcast:2 row_mask:0xf bank_mask:0xf
    s_nop 0
    s_waitcnt lgkmcnt(3)
    v_mfma_f32_16x16x32_bf16 v[16:19], v[8:11], v[56:59], v[16:19]
    v_and_b32_dpp v12, v20, v3 row_newbcast:3 row_mask:0xf bank_mask:0xf
    v_and_b32_dpp v13, v20, v4 row_newbcast:3 row_mask:0xf bank_mask:0xf
    v_and_b32_dpp v14, v20, v5 row_newbcast:3 row_mask:0xf bank_mask:0xf
    v_and_b32_dpp v15, v20, v6 row_newbcast:3 row_mask:0xf bank_mask:0xf
    s_nop 0
    s_waitcnt lgkmcnt(2)
    v_mfma_f32_16x16x32_bf16 v[16:19], v[12:15], v[60:63], v[16:19]
    v_and_b32_dpp v8, v20, v3 row_newbcast:4 row_mask:0xf bank_mask:0xf
    v_and_b32_dpp v9, v20, v4 row_newbcast:4 row_mask:0xf bank_mask:0xf
    v_and_b32_dpp v10, v20, v5 row_newbcast:4 row_mask:0xf bank_mask:0xf
    v_and_b32_dpp v11, v20, v6 row_newbcast:4 row_mask:0xf bank_mask:0xf
    s_nop 0
    s_waitcnt lgkmcnt(1)
    v_mfma_f32_16x16x32_bf16 v[16:19], v[8:11], v[64:67], v[16:19]
    v_and_b32_dpp v12, v20, v3 row_newbcast:5 row_mask:0xf bank_mask:0xf
    v_and_b32_dpp v13, v20, v4 row_newbcast:5 row_mask:0xf bank_mask:0xf
    v_and_b32_dpp v14, v20, v5 row_newbcast:5 row_mask:0xf bank_mask:0xf
    v_and_b32_dpp v15, v20, v6 row_newbcast:5 row_mask:0xf bank_mask:0xf
    s_nop 0
    s_waitcnt lgkmcnt(0)
    v_mfma_f32_16x16x32_bf16 v[16:19], v[12:15], v[68:71], v[16:19]
    v_and_b32_dpp v8, v20, v3 row_newbcast:6 row_mask:0xf bank_mask:0xf
    v_and_b32_dpp v9, v20, v4 row_newbcast:6 row_mask:0xf bank_mask:0xf
    v_and_b32_dpp v10, v20, v5 row_newbcast:6 row_mask:0xf bank_mask:0xf
    v_and_b32_dpp v11, v20, v6 row_newbcast:6 row_mask:0xf bank_mask:0xf
    s_nop 0
    s_waitcnt vmcnt(9)
    v_mfma_f32_16x16x32_bf16 v[16:19], v[8:11], v[88:91], v[16:19]
    v_and_b32_dpp v12, v20, v3 row_newbcast:7 row_mask:0xf bank_mask:0xf
    v_and_b32_dpp v13, v20, v4 row_newbcast:7 row_mask:0xf bank_mask:0xf
    v_and_b32_dpp v14, v20, v5 row_newbcast:7 row_mask:0xf bank_mask:0xf
    v_and_b32_dpp v15, v20, v6 row_newbcast:7 row_mask:0xf bank_mask:0xf
    s_nop 0
    s_waitcnt vmcnt(8)
    v_mfma_f32_16x16x32_bf16 v[16:19], v[12:15], v[92:95], v[16:19]
    v_and_b32_dpp v8, v20, v3 row_newbcast:8 row_mask:0xf bank_mask:0xf
    v_and_b32_dpp v9, v20, v4 row_newbcast:8 row_mask:0xf bank_mask:0xf
    v_and_b32_dpp v10, v20, v5 row_newbcast:8 row_mask:0xf bank_mask:0xf
    v_and_b32_dpp v11, v20, v6 row_newbcast:8 row_mask:0xf bank_mask:0xf
    s_nop 0
    s_waitcnt vmcnt(7)
    v_mfma_f32_16x16x32_bf16 v[16:19], v[8:11], v[96:99], v[16:19]
    v_and_b32_dpp v12, v20, v3 row_newbcast:9 row_mask:0xf bank_mask:0xf
    v_and_b32_dpp v13, v20, v4 row_newbcast:9 row_mask:0xf bank_mask:0xf
    v_and_b32_dpp v14, v20, v5 row_newbcast:9 row_mask:0xf bank_mask:0xf
    v_and_b32_dpp v15, v20, v6 row_newbcast:9 row_mask:0xf bank_mask:0xf
    s_nop 0
    s_waitcnt vmcnt(6)
    v_mfma_f32_16x16x32_bf16 v[16:19], v[12:15], v[100:103], v[16:19]
    v_and_b32_dpp v8, v20, v3 row_newbcast:10 row_mask:0xf bank_mask:0xf
    v_and_b32_dpp v9, v20, v4 row_newbcast:10 row_mask:0xf bank_mask:0xf
    v_and_b32_dpp v10, v20, v5 row_newbcast:10 row_mask:0xf bank_mask:0xf
    v_and_b32_dpp v11, v20, v6 row_newbcast:10 row_mask:0xf bank_mask:0xf
    s_nop 0
    s_waitcnt vmcnt(5)
    v_mfma_f32_16x16x32_bf16 v[16:19], v[8:11], v[104:107], v[16:19]
    v_and_b32_dpp v12, v20, v3 row_newbcast:11 row_mask:0xf bank_mask:0xf
    v_and_b32_dpp v13, v20, v4 row_newbcast:11 row_mask:0xf bank_mask:0xf
    v_and_b32_dpp v14, v20, v5 row_newbcast:11 row_mask:0xf bank_mask:0xf
    v_and_b32_dpp v15, v20, v6 row_newbcast:11 row_mask:0xf bank_mask:0xf
    s_nop 0
    s_waitcnt vmcnt(4)
    v_mfma_f32_16x16x32_bf16 v[16:19], v[12:15], v[108:111], v[16:19]
    v_and_b32_dpp v8, v20, v3 row_newbcast:12 row_mask:0xf bank_mask:0xf
    v_and_b32_dpp v9, v20, v4 row_newbcast:12 row_mask:0xf bank_mask:0xf
    v_and_b32_dpp v10, v20, v5 row_newbcast:12 row_mask:0xf bank_mask:0xf
    v_and_b32_dpp v11, v20, v6 row_newbcast:12 row_mask:0xf bank_mask:0xf
    s_nop 0
    s_waitcnt vmcnt(3)
    v_mfma_f32_16x16x32_bf16 v[16:19], v[8:11], v[112:115], v[16:19]
    v_and_b32_dpp v12, v20, v3 row_newbcast:13 row_mask:0xf bank_mask:0xf
    v_and_b32_dpp v13, v20, v4 row_newbcast:13 row_mask:0xf bank_mask:0xf
    v_and_b32_dpp v14, v20, v5 row_newbcast:13 row_mask:0xf bank_mask:0xf
    v_and_b32_dpp v15, v20, v6 row_newbcast:13 row_mask:0xf bank_mask:0xf
    s_nop 0
    s_waitcnt vmcnt(2)
    v_mfma_f32_16x16x32_bf16 v[16:19], v[12:15], v[116:119], v[16:19]
    v_and_b32_dpp v8, v20, v3 row_newbcast:14 row_mask:0xf bank_mask:0xf
    v_and_b32_dpp v9, v20, v4 row_newbcast:14 row_mask:0xf bank_mask:0xf
    v_and_b32_dpp v10, v20, v5 row_newbcast:14 row_mask:0xf bank_mask:0xf
    v_and_b32_dpp v11, v20, v6 row_newbcast:14 row_mask:0xf bank_mask:0xf
    s_nop 0
    s_waitcnt vmcnt(1)
    v_mfma_f32_16x16x32_bf16 v[16:19], v[8:11], v[120:123], v[16:19]
    v_and_b32_dpp v12, v20, v3 row_newbcast:15 row_mask:0xf bank_mask:0xf
    v_and_b32_dpp v13, v20, v4 row_newbcast:15 row_mask:0xf bank_mask:0xf
    v_and_b32_dpp v14, v20, v5 row_newbcast:15 row_mask:0xf bank_mask:0xf
    v_and_b32_dpp v15, v20, v6 row_newbcast:15 row_mask:0xf bank_mask:0xf
    s_nop 0
    s_waitcnt vmcnt(0)
    v_mfma_f32_16x16x32_bf16 v[16:19], v[12:15], v[124:127], v[16:19]
    s_mov_b32 exec_hi, 0
    s_nop 6
    ds_write_b128 v75, v[16:19] offset:0
    s_mov_b32 exec_hi, -1
    s_cmp_ge_u32 s31, 8
    s_cbranch_scc1 L_T_OTHER
    s_mov_b32 s56, s28
    s_and_b32 s57, s29, 0xffff
    s_mov_b32 s58, 0x500000
    s_mov_b32 s59, 0x20000
    s_lshl_b32 s16, s5, 3
    s_add_u32 s16, s16, s31
    s_mul_i32 s16, s16, 20480
    s_add_u32 s17, s16, 10240
    v_lshrrev_b32 v9, 1, v22
    v_and_b32 v10, 1, v22
    v_lshl_add_u32 v8, v9, 2, v10
    v_mul_u32_u24 v8, 1280, v8
    v_lshl_add_u32 v8, v0, 4, v8
    buffer_load_dwordx4 v[88:91], v8, s[56:59], s16 offen offset:0
    buffer_load_dwordx4 v[96:99], v8, s[56:59], s16 offen offset:256
    buffer_load_dwordx4 v[104:107], v8, s[56:59], s16 offen offset:512
    buffer_load_dwordx4 v[112:115], v8, s[56:59], s16 offen offset:768
    buffer_load_dwordx4 v[120:123], v8, s[56:59], s16 offen offset:1024
    buffer_load_dwordx4 v[92:95], v8, s[56:59], s17 offen offset:0
    buffer_load_dwordx4 v[100:103], v8, s[56:59], s17 offen offset:256
    buffer_load_dwordx4 v[108:111], v8, s[56:59], s17 offen offset:512
    buffer_load_dwordx4 v[116:119], v8, s[56:59], s17 offen offset:768
    buffer_load_dwordx4 v[124:127], v8, s[56:59], s17 offen offset:1024
    buffer_load_dwordx4 v[24:27], v8, s[56:59], s16 offen offset:2560
    buffer_load_dwordx4 v[32:35], v8, s[56:59], s16 offen offset:2816
    buffer_load_dwordx4 v[40:43], v8, s[56:59], s16 offen offset:3072
    buffer_load_dwordx4 v[48:51], v8, s[56:59], s16 offen offset:3328
    buffer_load_dwordx4 v[56:59], v8, s[56:59], s16 offen offset:3584
    buffer_load_dwordx4 v[28:31], v8, s[56:59], s17 offen offset:2560
    buffer_load_dwordx4 v[36:39], v8, s[56:59], s17 offen offset:2816
    buffer_load_dwordx4 v[44:47], v8, s[56:59], s17 offen offset:3072
    buffer_load_dwordx4 v[52:55], v8, s[56:59], s17 offen offset:3328
    buffer_load_dwordx4 v[60:63], v8, s[56:59], s17 offen offset:3584
    s_waitcnt lgkmcnt(0)
    v_mov_b32 v64, 0
    v_mov_b32 v65, 0
    v_mov_b32 v66, 0
    v_mov_b32 v67, 0
    v_mov_b32 v68, 0
    v_mov_b32 v69, 0
    v_mov_b32 v70, 0
    v_mov_b32 v71, 0
    v_mov_b32 v72, 0
    v_mov_b32 v73, 0
    v_mov_b32 v74, 0
    v_mov_b32 v75, 0
    v_mul_u32_u24 v84, 528, v0
    v_lshl_add_u32 v84, v22, 4, v84
    s_lshl_b32 s16, s31, 6
    v_add_u32 v84, s16, v84
    v_lshlrev_b32 v86, 3, v0
    v_mov_b32 v87, 0
    v_lshlrev_b32 v85, 9, v9
    v_lshl_add_u32 v85, v0, 5, v85
    v_lshl_add_u32 v85, v10, 4, v85
    s_add_u32 s16, s30, 49152
    v_add_u32 v85, s16, v85
    v_bfe_u32 v4, v0, 2, 1
    v_mul_u32_u24 v4, 0xffff, v4
    v_xor_b32 v3, 0xffff, v4
    v_lshlrev_b32 v5, 16, v3
    v_lshlrev_b32 v6, 16, v4
    v_cmp_lt_u32 vcc, 7, v0
    s_nop 1
    v_cndmask_b32 v76, 0, v3, vcc
    v_xor_b32 v3, v3, v76
    v_cndmask_b32 v77, 0, v4, vcc
    v_xor_b32 v4, v4, v77
    v_cndmask_b32 v78, 0, v5, vcc
    v_xor_b32 v5, v5, v78
    v_cndmask_b32 v79, 0, v6, vcc
    v_xor_b32 v6, v6, v79
    s_waitcnt vmcnt(0) lgkmcnt(0)
    s_cmp_lg_u32 s87, 2
    s_cbranch_scc1 L_NOGE
    v_mov_b32 v8, 0
    s_mov_b32 s17, 16777216
SP_11:
    ds_read_b32 v9, v8 offset:11604
    s_sub_u32 s17, s17, 1
    s_waitcnt lgkmcnt(0)
    v_readfirstlane_b32 s16, v9
    s_cmp_eq_u32 s17, 0
    s_cbranch_scc1 SPOK_12
    s_cmp_ge_u32 s16, 16
    s_cbranch_scc1 SPOK_12
    s_sleep 1
    s_branch SP_11
SPOK_12:
    s_mov_b32 s60, s32
    s_and_b32 s61, s33, 0xffff
    s_mov_b32 s62, 0x21c000
    s_mov_b32 s63, 0x20000
    s_mov_b32 s64, s34
    s_and_b32 s65, s35, 0xffff
    s_mov_b32 s66, 0x21c000
    s_mov_b32 s67, 0x20000
    v_lshrrev_b32 v10, 2, v1
    v_mul_u32_u24 v10, 3456, v10
    v_and_b32 v11, 3, v1
    v_lshl_add_u32 v10, v11, 4, v10
    s_mul_i32 s95, s31, 276480
    s_lshl_b32 s96, s88, 6
    s_add_u32 s95, s95, s96
    s_mul_i32 s96, s31, 5120
    s_add_u32 s16, s96, 121856
    s_mov_b32 m0, s16
    s_nop 0
    buffer_load_dwordx4 v10, s[60:63], s95 offen  lds
    s_add_u32 s95, s95, 55296
    s_add_u32 s16, s96, 122880
    s_mov_b32 m0, s16
    s_nop 0
    buffer_load_dwordx4 v10, s[60:63], s95 offen  lds
    s_add_u32 s95, s95, 55296
    s_add_u32 s16, s96, 123904
    s_mov_b32 m0, s16
    s_nop 0
    buffer_load_dwordx4 v10, s[60:63], s95 offen  lds
    s_add_u32 s95, s95, 55296
    s_add_u32 s16, s96, 124928
    s_mov_b32 m0, s16
    s_nop 0
    buffer_load_dwordx4 v10, s[60:63], s95 offen  lds
    s_add_u32 s95, s95, 55296
    s_add_u32 s16, s96, 125952
    s_mov_b32 m0, s16
    s_nop 0
    buffer_load_dwordx4 v10, s[60:63], s95 offen  lds
    s_add_u32 s95, s95, 55296
L_NOGE:
    s_cmp_lg_u32 s87, 3
    s_cbranch_scc1 L_NODE
    v_mov_b32 v8, 0
    s_mov_b32 s17, 16777216
SP_13:
    ds_read_b32 v9, v8 offset:11604
    s_sub_u32 s17, s17, 1
    s_waitcnt lgkmcnt(0)
    v_readfirstlane_b32 s16, v9
    s_cmp_eq_u32 s17, 0
    s_cbranch_scc1 SPOK_14
    s_cmp_ge_u32 s16, 16
    s_cbranch_scc1 SPOK_14
    s_sleep 1
    s_branch SP_13
SPOK_14:
    s_mov_b32 s60, s36
    s_and_b32 s61, s37, 0xffff
    s_mov_b32 s62, 0x21c000
    s_mov_b32 s63, 0x20000
    v_lshrrev_b32 v10, 1, v1
    v_mul_u32_u24 v10, 1280, v10
    v_and_b32 v11, 1, v1
    v_lshl_add_u32 v10, v11, 4, v10
    s_mul_i32 s89, s3, 163840
    s_lshl_b32 s90, s88, 5
    s_add_u32 s89, s89, s90
    s_lshl_b32 s92, s3, 12
    s_add_u32 s92, s92, 121856
    s_mov_b32 m0, s92
    s_add_u32 s92, s92, 1024
    buffer_load_dwordx4 v10, s[60:63], s89 offen lds
    s_add_u32 s89, s89, 40960
    s_mov_b32 m0, s92
    s_add_u32 s92, s92, 1024
    buffer_load_dwordx4 v10, s[60:63], s89 offen lds
    s_add_u32 s89, s89, 40960
    s_mov_b32 m0, s92
    s_add_u32 s92, s92, 1024
    buffer_load_dwordx4 v10, s[60:63], s89 offen lds
    s_add_u32 s89, s89, 40960
    s_mov_b32 m0, s92
    s_add_u32 s92, s92, 1024
    buffer_load_dwordx4 v10, s[60:63], s89 offen lds
    s_add_u32 s89, s89, 40960
L_NODE:
    v_mov_b32 v8, 0
    s_mov_b32 s17, 16777216
SP_15:
    ds_read_b32 v9, v8 offset:11608
    s_sub_u32 s17, s17, 1
    s_waitcnt lgkmcnt(0)
    v_readfirstlane_b32 s16, v9
    s_cmp_eq_u32 s17, 0
    s_cbranch_scc1 SPOK_16
    s_cmp_eq_u32 s16, 16
    s_cbranch_scc1 SPOK_16
    s_sleep 1
    s_branch SP_15
SPOK_16:
    ds_read_b64 v[8:9], v86 offset:11648
    ds_read_b32 v10, v87 offset:11588
    s_waitcnt lgkmcnt(0)
    v_sub_f32 v8, v8, v10
    v_mul_f32 v8, 0x3fb8aa3b, v8
    v_exp_f32 v8, v8
    s_nop 0
    v_mul_f32 v9, v9, v8
    s_nop 1
    v_add_f32_dpp v9, v9, v9 row_ror:8 row_mask:0xf bank_mask:0xf
    s_nop 1
    v_add_f32_dpp v9, v9, v9 row_ror:4 row_mask:0xf bank_mask:0xf
    s_nop 1
    v_add_f32_dpp v9, v9, v9 row_ror:2 row_mask:0xf bank_mask:0xf
    s_nop 1
    v_add_f32_dpp v9, v9, v9 row_ror:1 row_mask:0xf bank_mask:0xf
    v_rcp_f32 v9, v9
    s_nop 0
    v_mul_f32 v20, v8, v9
    v_mov_b32 v21, v20
    v_and_b32 v87, 3, v0
    v_mul_u32_u24 v87, 0x5555, v87
    s_setprio 3
    s_barrier
    ds_read_b128 v[16:19], v84 offset:0
    s_waitcnt lgkmcnt(0)
    v_pk_mul_f32 v[16:17], v[16:17], v[20:21]
    v_pk_mul_f32 v[18:19], v[18:19], v[20:21]
    s_nop 0
    v_add_f32_dpp v16, v16, v16 row_ror:8 row_mask:0xf bank_mask:0xf
    v_add_f32_dpp v17, v17, v17 row_ror:8 row_mask:0xf bank_mask:0xf
    v_add_f32_dpp v18, v18, v18 row_ror:8 row_mask:0xf bank_mask:0xf
    v_add_f32_dpp v19, v19, v19 row_ror:8 row_mask:0xf bank_mask:0xf
    v_add_f32_dpp v16, v16, v16 row_ror:4 row_mask:0xf bank_mask:0xf
    v_add_f32_dpp v17, v17, v17 row_ror:4 row_mask:0xf bank_mask:0xf
    v_add_f32_dpp v18, v18, v18 row_ror:4 row_mask:0xf bank_mask:0xf
    v_add_f32_dpp v19, v19, v19 row_ror:4 row_mask:0xf bank_mask:0xf
    v_add_f32_dpp v16, v16, v16 row_ror:2 row_mask:0xf bank_mask:0xf
    v_add_f32_dpp v17, v17, v17 row_ror:2 row_mask:0xf bank_mask:0xf
    v_add_f32_dpp v18, v18, v18 row_ror:2 row_mask:0xf bank_mask:0xf
    v_add_f32_dpp v19, v19, v19 row_ror:2 row_mask:0xf bank_mask:0xf
    v_add_f32_dpp v16, v16, v16 row_ror:1 row_mask:0xf bank_mask:0xf
    v_add_f32_dpp v17, v17, v17 row_ror:1 row_mask:0xf bank_mask:0xf
    v_add_f32_dpp v18, v18, v18 row_ror:1 row_mask:0xf bank_mask:0xf
    v_add_f32_dpp v19, v19, v19 row_ror:1 row_mask:0xf bank_mask:0xf
    v_cvt_pk_bf16_f32 v16, v16, v17
    v_and_b32 v8, v16, v3
    v_and_b32 v9, v16, v4
    v_and_b32 v10, v16, v5
    v_and_b32 v11, v16, v6
    v_cvt_pk_bf16_f32 v18, v18, v19
    s_nop 0
    v_smfmac_f32_16x16x64_bf16 v[72:75], v[8:11], v[120:127], v87
    v_and_b32 v12, v18, v3
    v_and_b32 v13, v18, v4
    v_and_b32 v14, v18, v5
    v_and_b32 v15, v18, v6
    v_smfmac_f32_16x16x64_bf16 v[64:67], v[8:11], v[88:95], v87
    v_and_b32 v80, v16, v76
    v_and_b32 v81, v16, v77
    v_and_b32 v82, v16, v78
    v_and_b32 v83, v16, v79
    v_smfmac_f32_16x16x64_bf16 v[72:75], v[12:15], v[56:63], v87
    v_and_b32 v76, v18, v76
    v_and_b32 v77, v18, v77
    v_and_b32 v78, v18, v78
    v_and_b32 v79, v18, v79
    v_smfmac_f32_16x16x64_bf16 v[64:67], v[12:15], v[24:31], v87
    v_smfmac_f32_16x16x64_bf16 v[64:67], v[80:83], v[96:103], v87
    v_smfmac_f32_16x16x64_bf16 v[64:67], v[76:79], v[32:39], v87
    v_smfmac_f32_16x16x64_bf16 v[68:71], v[8:11], v[104:111], v87
    s_mov_b32 exec_hi, 0
    ds_write_b128 v85, v[72:75] offset:2048
    s_mov_b32 exec_hi, -1
    v_smfmac_f32_16x16x64_bf16 v[68:71], v[12:15], v[40:47], v87
    v_smfmac_f32_16x16x64_bf16 v[68:71], v[80:83], v[112:119], v87
    v_smfmac_f32_16x16x64_bf16 v[68:71], v[76:79], v[48:55], v87
    s_nop 0
    ds_write_b128 v85, v[64:67]
    s_nop 5
    ds_write_b128 v85, v[68:71] offset:1024
    s_waitcnt lgkmcnt(0)
    s_barrier
    s_branch L_ROLES
L_T_OTHER:
    s_waitcnt lgkmcnt(0)
    s_barrier
    s_cmp_lg_u32 s87, 2
    s_cbranch_scc1 L_PRE_RED
    s_sub_u32 s16, s31, 8
    v_lshlrev_b32 v80, 3, v1
    s_mul_i32 s89, s16, 15360
    s_add_u32 s89, s89, 73216
    s_add_u32 s90, s89, 2560
    buffer_load_dwordx4 v[100:103], v2, s[52:55], s89 offen sc1
    buffer_load_dwordx4 v[104:107], v2, s[52:55], s89 offen offset:1024 sc1
    buffer_load_dwordx2 v[108:109], v80, s[52:55], s89 offen offset:2048 sc1
    buffer_load_dwordx4 v[88:91], v2, s[52:55], s90 offen sc1
    buffer_load_dwordx4 v[92:95], v2, s[52:55], s90 offen offset:1024 sc1
    buffer_load_dwordx2 v[96:97], v80, s[52:55], s90 offen offset:2048 sc1
    s_lshl_b32 s92, s16, 12
    s_and_b32 s17, s92, -8192
    s_add_u32 s92, s92, s17
    s_add_u32 s92, s92, s98
    s_add_u32 s92, s92, 1441792
    s_mul_i32 s16, s16, 1408
    v_add_u32 v84, s16, v80
    v_lshlrev_b32 v85, 2, v1
    v_add_u32 v85, s16, v85
    v_and_b32 v12, 1, v1
    v_lshlrev_b32 v12, 1, v12
    v_mov_b32 v110, s10
    v_mov_b32 v13, s11
    v_cmp_lt_u32 vcc, 1, v12
    s_nop 1
    v_cndmask_b32 v110, v110, v13, vcc
    v_and_b32 v13, 1, v12
    v_lshlrev_b32 v13, 4, v13
    v_lshrrev_b32 v110, v13, v110
    v_and_b32 v110, 0xffff, v110
    v_add_u32 v12, 1, v12
    v_mov_b32 v111, s10
    v_mov_b32 v13, s11
    v_cmp_lt_u32 vcc, 1, v12
    s_nop 1
    v_cndmask_b32 v111, v111, v13, vcc
    v_and_b32 v13, 1, v12
    v_lshlrev_b32 v13, 4, v13
    v_lshrrev_b32 v111, v13, v111
    v_and_b32 v111, 0xffff, v111
    s_branch L_PRE_DONE
L_PRE_RED:
    s_cmp_lg_u32 s87, 1
    s_cbranch_scc1 L_PRE_DONE
    s_sub_u32 s16, s31, 10
    s_cmp_gt_u32 s16, 1
    s_cbranch_scc1 L_PRE_DONE
    s_lshl_b32 s88, s88, 1
    s_add_u32 s88, s88, s16
    s_mul_i32 s16, s88, 205
    s_lshr_b32 s16, s16, 12
    s_mul_i32 s17, s16, 20
    s_sub_u32 s17, s88, s17
    s_mov_b32 s60, s20
    s_and_b32 s61, s21, 0xffff
    s_mov_b32 s62, 0x2800
    s_mov_b32 s63, 0x20000
    v_and_b32 v8, 7, v0
    v_lshl_add_u32 v80, v8, 2, v22
    v_lshlrev_b32 v10, 1, v80
    v_lshlrev_b32 v80, 2, v80
    s_mul_i32 s89, s16, 1280
    s_lshl_b32 s90, s17, 6
    s_add_u32 s89, s89, s90
    s_mul_i32 s90, s16, 15360
    s_lshl_b32 s91, s17, 7
    s_add_u32 s90, s90, s91
    s_add_u32 s90, s90, 70656
    buffer_load_ushort v81, v10, s[60:63], s89 offen
    buffer_load_dword v82, v80, s[52:55], s90 offen sc1
    s_lshl_b32 s89, s16, 12
    s_and_b32 s92, s89, -8192
    s_add_u32 s89, s89, s92
    s_add_u32 s89, s89, s91
    s_add_u32 s89, s89, 1441792
    s_and_b32 s92, s16, 3
    s_mul_i32 s92, s92, 20
    s_add_u32 s92, s92, s17
    s_lshl_b32 s92, s92, 12
    s_and_b32 s93, s92, -8192
    s_add_u32 s92, s92, s93
    s_lshr_b32 s93, s16, 2
    s_xor_b32 s93, s93, s99
    s_lshl_b32 s93, s93, 13
    s_add_u32 s92, s92, s93
    s_add_u32 s92, s92, 524288
L_PRE_DONE:
    s_barrier
    s_cmp_lt_u32 s31, 13
    s_cbranch_scc1 L_ROLES
    ds_read_b128 v[24:27], v74 offset:0
    ds_read_b128 v[28:31], v74 offset:6144
    ds_read_b128 v[32:35], v74 offset:12288
    ds_read_b128 v[36:39], v74 offset:18432
    ds_read_b128 v[40:43], v74 offset:24576
    ds_read_b128 v[44:47], v74 offset:30720
    ds_read_b128 v[48:51], v74 offset:36864
    ds_read_b128 v[52:55], v74 offset:43008
    s_cmp_eq_u32 s31, 15
    s_cselect_b32 exec_hi, 0, -1
    s_waitcnt lgkmcnt(6)
    v_pk_add_f32 v[24:25], v[24:25], v[28:29]
    v_pk_add_f32 v[26:27], v[26:27], v[30:31]
    s_waitcnt lgkmcnt(5)
    v_pk_add_f32 v[24:25], v[24:25], v[32:33]
    v_pk_add_f32 v[26:27], v[26:27], v[34:35]
    s_waitcnt lgkmcnt(4)
    v_pk_add_f32 v[24:25], v[24:25], v[36:37]
    v_pk_add_f32 v[26:27], v[26:27], v[38:39]
    s_waitcnt lgkmcnt(3)
    v_pk_add_f32 v[24:25], v[24:25], v[40:41]
    v_pk_add_f32 v[26:27], v[26:27], v[42:43]
    s_waitcnt lgkmcnt(2)
    v_pk_add_f32 v[24:25], v[24:25], v[44:45]
    v_pk_add_f32 v[26:27], v[26:27], v[46:47]
    s_waitcnt lgkmcnt(1)
    v_pk_add_f32 v[24:25], v[24:25], v[48:49]
    v_pk_add_f32 v[26:27], v[26:27], v[50:51]
    s_waitcnt lgkmcnt(0)
    v_pk_add_f32 v[24:25], v[24:25], v[52:53]
    v_pk_add_f32 v[26:27], v[26:27], v[54:55]
    v_and_or_b32 v56, v24, -16, s80
    v_and_or_b32 v57, v25, -16, s81
    v_and_or_b32 v58, v26, -16, s82
    v_and_or_b32 v59, v27, -16, s83
    buffer_store_dwordx4 v[56:59], v76, s[52:55], s85 offen sc1
    s_mov_b64 exec, -1
L_ROLES:
    s_cmp_eq_u32 s87, 2
    s_cbranch_scc1 L_GU
    s_cmp_eq_u32 s87, 3
    s_cbranch_scc1 L_DOWN
    s_cmp_lg_u32 s87, 1
    s_cbranch_scc1 L_END
    s_sub_u32 s16, s31, 10
    s_cmp_gt_u32 s16, 1
    s_cbranch_scc1 L_END
    s_branch L_RED_GA_IN
L_RED_GA:
    buffer_load_dword v82, v80, s[52:55], s90 offen sc1
L_RED_GA_IN:
    s_waitcnt vmcnt(0)
    v_xor_b32 v82, v82, v7
    v_mov_b32 v13, v82
    v_and_b32 v13, 0xffff, v13
    v_cmp_ne_u32 vcc, 0, v13
    s_sub_u32 s84, s84, 1
    s_cmp_lt_i32 s84, 0
    s_cbranch_scc1 OK_17
    s_cbranch_vccnz L_RED_GA
OK_17:
    v_lshlrev_b32 v81, 16, v81
L_RED_POLL:
    buffer_load_dwordx4 v[40:43], v2, s[52:55], s92 offen offset:0 sc1
    buffer_load_dwordx4 v[44:47], v2, s[52:55], s92 offen offset:1024 sc1
    buffer_load_dwordx4 v[48:51], v2, s[52:55], s92 offen offset:2048 sc1
    buffer_load_dwordx4 v[52:55], v2, s[52:55], s92 offen offset:3072 sc1
    s_waitcnt vmcnt(0)
    v_xor_b32 v24, s80, v40
    v_xor_b32 v25, s81, v41
    v_xor_b32 v26, s82, v42
    v_xor_b32 v27, s83, v43
    v_xor_b32 v28, s80, v44
    v_xor_b32 v29, s81, v45
    v_xor_b32 v30, s82, v46
    v_xor_b32 v31, s83, v47
    v_xor_b32 v32, s80, v48
    v_xor_b32 v33, s81, v49
    v_xor_b32 v34, s82, v50
    v_xor_b32 v35, s83, v51
    v_xor_b32 v36, s80, v52
    v_xor_b32 v37, s81, v53
    v_xor_b32 v38, s82, v54
    v_xor_b32 v39, s83, v55
    v_or3_b32 v13, v24, v25, v26
    v_or3_b32 v13, v13, v27, v28
    v_or3_b32 v13, v13, v29, v30
    v_or3_b32 v13, v13, v31, v32
    v_or3_b32 v13, v13, v33, v34
    v_or3_b32 v13, v13, v35, v36
    v_or3_b32 v13, v13, v37, v38
    v_or_b32 v13, v13, v39
    v_and_b32 v13, 15, v13
    v_cmp_ne_u32 vcc, 0, v13
    s_cbranch_vccz L_RED_POLL_D0
    s_sub_u32 s84, s84, 1
    s_cmp_lt_i32 s84, 0
    s_cbranch_scc0 L_RED_POLL
L_RED_POLL_D0:
L_RED_POLL_OK:
    v_pk_add_f32 v[24:25], v[24:25], v[28:29]
    v_pk_add_f32 v[32:33], v[32:33], v[36:37]
    v_pk_add_f32 v[26:27], v[26:27], v[30:31]
    v_pk_add_f32 v[34:35], v[34:35], v[38:39]
    v_pk_add_f32 v[24:25], v[24:25], v[32:33]
    v_pk_add_f32 v[26:27], v[26:27], v[34:35]
    s_nop 1
    v_permlane32_swap_b32 v24, v26
    v_permlane32_swap_b32 v25, v27
    s_nop 0
    v_pk_add_f32 v[24:25], v[24:25], v[26:27]
    s_nop 1
    v_permlane16_swap_b32 v24, v25
    s_nop 0
    v_add_f32 v24, v24, v25
    s_nop 1
    v_add_f32_dpp v24, v24, v24 row_ror:8 row_mask:0xf bank_mask:0xf
    v_fma_f32 v24, v82, v24, v81
    v_cvt_pk_bf16_f32 v24, 0, v24
    v_or_b32 v24, v24, v7
    s_mov_b32 exec_lo, 0x00ff00ff
    s_mov_b32 exec_hi, 0x00ff00ff
    buffer_store_dword v24, v80, s[52:55], s89 offen sc1
    s_add_u32 s89, s89, 0x2000
    buffer_store_dword v24, v80, s[52:55], s89 offen sc1
    s_add_u32 s89, s89, 0xe000
    buffer_store_dword v24, v80, s[52:55], s89 offen sc1
    s_add_u32 s89, s89, 0x2000
    buffer_store_dword v24, v80, s[52:55], s89 offen sc1
    s_mov_b64 exec, -1
    s_endpgm
L_GU:
    s_barrier
    s_cmp_ge_u32 s31, 8
    s_cbranch_scc1 L_GU_LN
    s_mov_b32 s60, s32
    s_and_b32 s61, s33, 0xffff
    s_mov_b32 s62, 0x21c000
    s_mov_b32 s63, 0x20000
    s_mov_b32 s64, s34
    s_and_b32 s65, s35, 0xffff
    s_mov_b32 s66, 0x21c000
    s_mov_b32 s67, 0x20000
    v_lshrrev_b32 v10, 2, v1
    v_mul_u32_u24 v10, 3456, v10
    v_and_b32 v11, 3, v1
    v_lshl_add_u32 v10, v11, 4, v10
    s_mul_i32 s95, s31, 276480
    s_lshl_b32 s96, s88, 6
    s_add_u32 s95, s95, s96
    s_mul_i32 s96, s31, 5120
    s_add_u32 s16, s96, 23552
    s_mov_b32 m0, s16
    s_nop 0
    buffer_load_dwordx4 v10, s[64:67], s95 offen  lds
    s_add_u32 s95, s95, 55296
    s_add_u32 s16, s96, 24576
    s_mov_b32 m0, s16
    s_nop 0
    buffer_load_dwordx4 v10, s[64:67], s95 offen  lds
    s_add_u32 s95, s95, 55296
    s_add_u32 s16, s96, 25600
    s_mov_b32 m0, s16
    s_nop 0
    buffer_load_dwordx4 v10, s[64:67], s95 offen  lds
    s_add_u32 s95, s95, 55296
    s_add_u32 s16, s96, 26624
    s_mov_b32 m0, s16
    s_nop 0
    buffer_load_dwordx4 v10, s[64:67], s95 offen  lds
    s_add_u32 s95, s95, 55296
    s_add_u32 s16, s96, 27648
    s_mov_b32 m0, s16
    s_nop 0
    buffer_load_dwordx4 v10, s[64:67], s95 offen  lds
    s_add_u32 s95, s95, 55296
    s_lshr_b32 s18, s31, 1
    s_and_b32 s19, s31, 1
    s_lshl_b32 s16, s18, 12
    s_lshl_b32 s17, s19, 5
    s_add_u32 s16, s16, s17
    s_add_u32 s16, s16, 23552
    v_lshrrev_b32 v12, 1, v22
    v_lshlrev_b32 v12, 4, v12
    v_and_b32 v11, 1, v22
    v_lshl_add_u32 v12, v11, 2, v12
    v_bfe_u32 v11, v0, 2, 1
    v_add_u32 v12, v12, v11
    v_and_b32 v11, 8, v0
    v_add_u32 v12, v12, v11
    v_lshlrev_b32 v12, 6, v12
    v_and_b32 v11, 3, v0
    v_lshl_add_u32 v12, v11, 3, v12
    v_add_u32 v12, s16, v12
    v_add_u32 v13, 98304, v12
    v_and_b32 v81, 7, v0
    v_lshlrev_b32 v83, 5, v81
    v_lshl_add_u32 v83, v22, 3, v83
    v_mul_u32_u24 v81, 1408, v81
    v_lshrrev_b32 v11, 3, v0
    v_lshl_add_u32 v81, v11, 4, v81
    v_lshl_add_u32 v81, v22, 5, v81
    s_lshl_b32 s16, s18, 7
    v_add_u32 v81, s16, v81
    s_lshl_b32 s16, s31, 10
    v_add_u32 v82, s16, v2
    v_lshrrev_b32 v84, 2, v0
    v_lshlrev_b32 v84, 8, v84
    v_lshl_add_u32 v84, v22, 6, v84
    v_and_b32 v11, 3, v0
    v_lshl_add_u32 v84, v11, 2, v84
    v_add_u32 v84, s16, v84
    v_lshrrev_b32 v85, 3, v0
    v_mul_u32_u24 v85, 0xaaaa, v85
    v_add_u32 v85, 0x4444, v85
    v_mov_b32 v88, 0
    v_mov_b32 v89, 0
    v_mov_b32 v90, 0
    v_mov_b32 v91, 0
    v_mov_b32 v92, 0
    v_mov_b32 v93, 0
    v_mov_b32 v94, 0
    v_mov_b32 v95, 0
    s_lshl_b32 s93, s88, 1
    s_add_u32 s93, s93, s31
    s_lshl_b32 s93, s93, 8
    s_and_b32 s16, s93, -8192
    s_add_u32 s93, s93, s16
    s_add_u32 s93, s93, 1703936
    v_mov_b32 v8, 0
    v_mov_b32 v9, 1
    s_waitcnt vmcnt(0)
    s_mov_b64 exec, 1
    ds_add_u32 v8, v9 offset:11612
    s_mov_b64 exec, -1
    v_mov_b32 v8, 0
    s_mov_b32 s17, 16777216
SP_18:
    ds_read_b32 v9, v8 offset:11612
    s_sub_u32 s17, s17, 1
    s_waitcnt lgkmcnt(0)
    v_readfirstlane_b32 s16, v9
    s_cmp_eq_u32 s17, 0
    s_cbranch_scc1 SPOK_19
    s_cmp_eq_u32 s16, 8
    s_cbranch_scc1 SPOK_19
    s_sleep 1
    s_branch SP_18
SPOK_19:
    ds_read_b64_tr_b16 v[24:25], v13 offset:0
    ds_read_b64_tr_b16 v[26:27], v13 offset:128
    ds_read_b64_tr_b16 v[28:29], v13 offset:2048
    ds_read_b64_tr_b16 v[30:31], v13 offset:2176
    ds_read_b64_tr_b16 v[32:33], v12 offset:0
    ds_read_b64_tr_b16 v[34:35], v12 offset:128
    ds_read_b64_tr_b16 v[36:37], v12 offset:2048
    ds_read_b64_tr_b16 v[38:39], v12 offset:2176
    s_waitcnt lgkmcnt(4)
    ds_read_b64_tr_b16 v[40:41], v13 offset:16384
    ds_read_b64_tr_b16 v[42:43], v13 offset:16512
    ds_read_b64_tr_b16 v[44:45], v13 offset:18432
    ds_read_b64_tr_b16 v[46:47], v13 offset:18560
    ds_read_b64_tr_b16 v[48:49], v12 offset:16384
    ds_read_b64_tr_b16 v[50:51], v12 offset:16512
    ds_read_b64_tr_b16 v[52:53], v12 offset:18432
    ds_read_b64_tr_b16 v[54:55], v12 offset:18560
    s_waitcnt lgkmcnt(4)
    s_cmp_ge_u32 s31, 4
    s_cbranch_scc1 L_GU_B1
    ds_read_b64_tr_b16 v[56:57], v13 offset:32768
    ds_read_b64_tr_b16 v[58:59], v13 offset:32896
    ds_read_b64_tr_b16 v[60:61], v13 offset:34816
    ds_read_b64_tr_b16 v[62:63], v13 offset:34944
    ds_read_b64_tr_b16 v[64:65], v12 offset:32768
    ds_read_b64_tr_b16 v[66:67], v12 offset:32896
    ds_read_b64_tr_b16 v[68:69], v12 offset:34816
    ds_read_b64_tr_b16 v[70:71], v12 offset:34944
    s_waitcnt lgkmcnt(4)
    s_branch L_GU_B1
L_GU_LN:
    s_branch L_GU_MOD_IN
L_GU_MOD:
    buffer_load_dwordx4 v[100:103], v2, s[52:55], s89 offen sc1
    buffer_load_dwordx4 v[104:107], v2, s[52:55], s89 offen offset:1024 sc1
    buffer_load_dwordx2 v[108:109], v80, s[52:55], s89 offen offset:2048 sc1
    buffer_load_dwordx4 v[88:91], v2, s[52:55], s90 offen sc1
    buffer_load_dwordx4 v[92:95], v2, s[52:55], s90 offen offset:1024 sc1
    buffer_load_dwordx2 v[96:97], v80, s[52:55], s90 offen offset:2048 sc1
L_GU_MOD_IN:
    s_waitcnt vmcnt(0)
    v_xor_b32 v100, s76, v100
    v_xor_b32 v101, s77, v101
    v_xor_b32 v102, s78, v102
    v_xor_b32 v103, s79, v103
    v_xor_b32 v104, s76, v104
    v_xor_b32 v105, s77, v105
    v_xor_b32 v106, s78, v106
    v_xor_b32 v107, s79, v107
    v_xor_b32 v108, v110, v108
    v_xor_b32 v109, v111, v109
    v_xor_b32 v88, s76, v88
    v_xor_b32 v89, s77, v89
    v_xor_b32 v90, s78, v90
    v_xor_b32 v91, s79, v91
    v_xor_b32 v92, s76, v92
    v_xor_b32 v93, s77, v93
    v_xor_b32 v94, s78, v94
    v_xor_b32 v95, s79, v95
    v_xor_b32 v96, v110, v96
    v_xor_b32 v97, v111, v97
    v_or3_b32 v12, v100, v101, v102
    v_or3_b32 v12, v12, v103, v104
    v_or3_b32 v12, v12, v105, v106
    v_or3_b32 v12, v12, v107, v108
    v_or3_b32 v12, v12, v109, v88
    v_or3_b32 v12, v12, v89, v90
    v_or3_b32 v12, v12, v91, v92
    v_or3_b32 v12, v12, v93, v94
    v_or3_b32 v12, v12, v95, v96
    v_or_b32 v12, v12, v97
    v_and_b32 v12, 0xffff, v12
    v_cmp_ne_u32 vcc, 0, v12
    s_sub_u32 s84, s84, 1
    s_cmp_lt_i32 s84, 0
    s_cbranch_scc1 OK_20
    s_cbranch_vccnz L_GU_MOD
OK_20:
    v_add_f32 v88, 1.0, v88
    v_add_f32 v89, 1.0, v89
    v_add_f32 v90, 1.0, v90
    v_add_f32 v91, 1.0, v91
    v_add_f32 v92, 1.0, v92
    v_add_f32 v93, 1.0, v93
    v_add_f32 v94, 1.0, v94
    v_add_f32 v95, 1.0, v95
    v_add_f32 v96, 1.0, v96
    v_add_f32 v97, 1.0, v97
    v_cvt_pk_bf16_f32 v89, v88, v89
    v_cvt_pk_bf16_f32 v91, v90, v91
    v_cvt_pk_bf16_f32 v93, v92, v93
    v_cvt_pk_bf16_f32 v95, v94, v95
    v_cvt_pk_bf16_f32 v97, v96, v97
    v_lshlrev_b32 v88, 16, v89
    v_and_b32 v89, 0xffff0000, v89
    v_lshlrev_b32 v90, 16, v91
    v_and_b32 v91, 0xffff0000, v91
    v_lshlrev_b32 v92, 16, v93
    v_and_b32 v93, 0xffff0000, v93
    v_lshlrev_b32 v94, 16, v95
    v_and_b32 v95, 0xffff0000, v95
    v_lshlrev_b32 v96, 16, v97
    v_and_b32 v97, 0xffff0000, v97
L_GU_POLL:
    buffer_load_dwordx4 v[48:51], v2, s[52:55], s92 offen sc1
    buffer_load_dwordx4 v[52:55], v2, s[52:55], s92 offen offset:1024 sc1
    buffer_load_dwordx2 v[56:57], v80, s[52:55], s92 offen offset:2048 sc1
    s_waitcnt vmcnt(0)
    v_xor_b32 v24, s76, v48
    v_xor_b32 v25, s77, v49
    v_xor_b32 v26, s78, v50
    v_xor_b32 v27, s79, v51
    v_xor_b32 v28, s76, v52
    v_xor_b32 v29, s77, v53
    v_xor_b32 v30, s78, v54
    v_xor_b32 v31, s79, v55
    v_xor_b32 v32, v110, v56
    v_xor_b32 v33, v111, v57
    v_or3_b32 v36, v24, v25, v26
    v_or3_b32 v36, v36, v27, v28
    v_or3_b32 v36, v36, v29, v30
    v_or3_b32 v36, v36, v31, v32
    v_or_b32 v36, v36, v33
    v_and_b32 v36, 0xffff, v36
    v_cmp_ne_u32 vcc, 0, v36
    s_cbranch_vccz L_GU_POLL_D0
    s_sub_u32 s84, s84, 1
    s_cmp_lt_i32 s84, 0
    s_cbranch_scc0 L_GU_POLL
L_GU_POLL_D0:
L_GU_POLL_OK:
    v_readfirstlane_b32 s18, v24
    v_mov_b32 v16, 0x3acccccd
    v_mov_b32 v17, 0x3727c5ac
    v_pk_add_f32 v[24:25], v[24:25], s[18:19] op_sel_hi:[1,0] neg_lo:[0,1] neg_hi:[0,1]
    v_pk_add_f32 v[26:27], v[26:27], s[18:19] op_sel_hi:[1,0] neg_lo:[0,1] neg_hi:[0,1]
    v_pk_add_f32 v[28:29], v[28:29], s[18:19] op_sel_hi:[1,0] neg_lo:[0,1] neg_hi:[0,1]
    v_pk_add_f32 v[30:31], v[30:31], s[18:19] op_sel_hi:[1,0] neg_lo:[0,1] neg_hi:[0,1]
    v_pk_add_f32 v[32:33], v[32:33], s[18:19] op_sel_hi:[1,0] neg_lo:[0,1] neg_hi:[0,1]
    v_pk_mul_f32 v[12:13], v[24:25], v[24:25]
    v_pk_add_f32 v[10:11], v[24:25], v[26:27]
    v_pk_fma_f32 v[12:13], v[26:27], v[26:27], v[12:13]
    v_pk_add_f32 v[10:11], v[10:11], v[28:29]
    v_pk_fma_f32 v[12:13], v[28:29], v[28:29], v[12:13]
    v_pk_add_f32 v[10:11], v[10:11], v[30:31]
    v_pk_fma_f32 v[12:13], v[30:31], v[30:31], v[12:13]
    v_pk_add_f32 v[10:11], v[10:11], v[32:33]
    v_pk_fma_f32 v[12:13], v[32:33], v[32:33], v[12:13]
    v_add_f32 v8, v10, v11
    v_add_f32 v9, v12, v13
    v_pk_mul_f32 v[24:25], v[24:25], v[88:89]
    v_add_f32_dpp v8, v8, v8 row_ror:8 row_mask:0xf bank_mask:0xf
    v_add_f32_dpp v9, v9, v9 row_ror:8 row_mask:0xf bank_mask:0xf
    v_pk_mul_f32 v[26:27], v[26:27], v[90:91]
    v_add_f32_dpp v8, v8, v8 row_ror:4 row_mask:0xf bank_mask:0xf
    v_add_f32_dpp v9, v9, v9 row_ror:4 row_mask:0xf bank_mask:0xf
    v_pk_mul_f32 v[28:29], v[28:29], v[92:93]
    v_add_f32_dpp v8, v8, v8 row_ror:2 row_mask:0xf bank_mask:0xf
    v_add_f32_dpp v9, v9, v9 row_ror:2 row_mask:0xf bank_mask:0xf
    v_pk_mul_f32 v[30:31], v[30:31], v[94:95]
    v_add_f32_dpp v8, v8, v8 row_ror:1 row_mask:0xf bank_mask:0xf
    v_add_f32_dpp v9, v9, v9 row_ror:1 row_mask:0xf bank_mask:0xf
    v_pk_mul_f32 v[32:33], v[32:33], v[96:97]
    v_add_f32_dpp v8, v8, v8 row_bcast:15 row_mask:0xa bank_mask:0xf
    v_add_f32_dpp v9, v9, v9 row_bcast:15 row_mask:0xa bank_mask:0xf
    s_nop 0
    v_add_f32_dpp v8, v8, v8 row_bcast:31 row_mask:0xc bank_mask:0xf
    v_add_f32_dpp v9, v9, v9 row_bcast:31 row_mask:0xc bank_mask:0xf
    v_readlane_b32 s16, v8, 63
    v_readlane_b32 s17, v9, 63
    s_nop 0
    v_mul_f32 v8, s16, v16
    v_mul_f32 v9, s17, v16
    v_fma_f32 v9, -v8, v8, v9
    v_max_f32 v9, 0, v9
    v_add_f32 v9, v9, v17
    v_rsq_f32 v14, v9
    s_nop 0
    v_mul_f32 v10, v8, v14
    v_pk_fma_f32 v[24:25], v[24:25], v[14:15], v[100:101] op_sel_hi:[1,0,1]
    v_pk_fma_f32 v[26:27], v[26:27], v[14:15], v[102:103] op_sel_hi:[1,0,1]
    v_pk_fma_f32 v[28:29], v[28:29], v[14:15], v[104:105] op_sel_hi:[1,0,1]
    v_pk_fma_f32 v[30:31], v[30:31], v[14:15], v[106:107] op_sel_hi:[1,0,1]
    v_pk_fma_f32 v[32:33], v[32:33], v[14:15], v[108:109] op_sel_hi:[1,0,1]
    v_pk_fma_f32 v[24:25], v[88:89], v[10:11], v[24:25] op_sel_hi:[1,0,1] neg_lo:[0,1,0] neg_hi:[0,1,0]
    v_pk_fma_f32 v[26:27], v[90:91], v[10:11], v[26:27] op_sel_hi:[1,0,1] neg_lo:[0,1,0] neg_hi:[0,1,0]
    v_pk_fma_f32 v[28:29], v[92:93], v[10:11], v[28:29] op_sel_hi:[1,0,1] neg_lo:[0,1,0] neg_hi:[0,1,0]
    v_pk_fma_f32 v[30:31], v[94:95], v[10:11], v[30:31] op_sel_hi:[1,0,1] neg_lo:[0,1,0] neg_hi:[0,1,0]
    v_pk_fma_f32 v[32:33], v[96:97], v[10:11], v[32:33] op_sel_hi:[1,0,1] neg_lo:[0,1,0] neg_hi:[0,1,0]
    v_cvt_pk_bf16_f32 v36, v24, v25
    v_cvt_pk_bf16_f32 v37, v26, v27
    v_cvt_pk_bf16_f32 v38, v28, v29
    v_cvt_pk_bf16_f32 v39, v30, v31
    v_cvt_pk_bf16_f32 v40, v32, v33
    ds_write_b64 v84, v[36:37] offset:12288
    ds_write_b64 v84, v[38:39] offset:12800
    ds_write_b32 v85, v40 offset:13312
L_GU_B1:
    s_waitcnt lgkmcnt(0)
    s_barrier
    s_cmp_ge_u32 s31, 8
    s_cbranch_scc1 L_END
    ds_read_b128 v[8:11], v81 offset:12288
    ds_read_b128 v[12:15], v81 offset:12800
    ds_read_b128 v[16:19], v81 offset:13312
    s_waitcnt lgkmcnt(2)
    v_smfmac_f32_16x16x64_bf16 v[88:91], v[8:11], v[24:31], v85
    v_smfmac_f32_16x16x64_bf16 v[92:95], v[8:11], v[32:39], v85
    s_waitcnt lgkmcnt(1)
    v_smfmac_f32_16x16x64_bf16 v[88:91], v[12:15], v[40:47], v85
    v_smfmac_f32_16x16x64_bf16 v[92:95], v[12:15], v[48:55], v85
    s_cmp_ge_u32 s31, 4
    s_cbranch_scc1 L_GU_M2
    s_waitcnt lgkmcnt(0)
    v_smfmac_f32_16x16x64_bf16 v[88:91], v[16:19], v[56:63], v85
    v_smfmac_f32_16x16x64_bf16 v[92:95], v[16:19], v[64:71], v85
L_GU_M2:
    s_nop 7
    v_permlane32_swap_b32 v88, v92
    v_permlane32_swap_b32 v89, v93
    v_permlane32_swap_b32 v90, v94
    v_permlane32_swap_b32 v91, v95
    v_pk_add_f32 v[88:89], v[88:89], v[92:93]
    v_pk_add_f32 v[90:91], v[90:91], v[94:95]
    ds_write2_b32 v84, v88, v89 offset0:0 offset1:4
    ds_write2_b32 v84, v90, v91 offset0:8 offset1:12
    s_waitcnt lgkmcnt(0)
    s_barrier
    s_cmp_gt_u32 s31, 1
    s_cbranch_scc1 L_END
    ds_read_b128 v[24:27], v82 offset:0
    ds_read_b128 v[28:31], v82 offset:2048
    ds_read_b128 v[32:35], v82 offset:4096
    ds_read_b128 v[36:39], v82 offset:6144
    s_waitcnt lgkmcnt(2)
    v_pk_add_f32 v[24:25], v[24:25], v[28:29]
    v_pk_add_f32 v[26:27], v[26:27], v[30:31]
    s_waitcnt lgkmcnt(0)
    v_pk_add_f32 v[32:33], v[32:33], v[36:37]
    v_pk_add_f32 v[34:35], v[34:35], v[38:39]
    v_pk_add_f32 v[24:25], v[24:25], v[32:33]
    v_pk_add_f32 v[26:27], v[26:27], v[34:35]
    v_max_f32 v28, 0, v24
    v_max_f32 v29, 0, v25
    v_max_f32 v30, 0, v26
    v_max_f32 v31, 0, v27
    v_mul_f32_dpp v28, v24, v28 row_ror:8 row_mask:0xf bank_mask:0xf
    v_mul_f32_dpp v29, v25, v29 row_ror:8 row_mask:0xf bank_mask:0xf
    v_mul_f32_dpp v30, v26, v30 row_ror:8 row_mask:0xf bank_mask:0xf
    v_mul_f32_dpp v31, v27, v31 row_ror:8 row_mask:0xf bank_mask:0xf
    v_cvt_pk_bf16_f32 v32, v28, v29
    v_cvt_pk_bf16_f32 v33, v30, v31
    s_mov_b32 exec_lo, 0x00ff00ff
    s_mov_b32 exec_hi, 0x00ff00ff
    buffer_store_dwordx2 v[32:33], v83, s[52:55], s93 offen sc1
    s_add_u32 s93, s93, 0x2000
    buffer_store_dwordx2 v[32:33], v83, s[52:55], s93 offen sc1
    s_add_u32 s93, s93, 0xe000
    buffer_store_dwordx2 v[32:33], v83, s[52:55], s93 offen sc1
    s_add_u32 s93, s93, 0x2000
    buffer_store_dwordx2 v[32:33], v83, s[52:55], s93 offen sc1
    s_mov_b64 exec, -1
    s_endpgm
L_DOWN:
    s_barrier
    s_mov_b32 s60, s36
    s_and_b32 s61, s37, 0xffff
    s_mov_b32 s62, 0x21c000
    s_mov_b32 s63, 0x20000
    s_mov_b32 s64, s42
    s_and_b32 s65, s43, 0xffff
    s_mov_b32 s66, 0x2800
    s_mov_b32 s67, 0x20000
    v_lshrrev_b32 v10, 1, v1
    v_mul_u32_u24 v10, 1280, v10
    v_and_b32 v11, 1, v1
    v_lshl_add_u32 v10, v11, 4, v10
    s_mul_i32 s89, s3, 81920
    s_lshl_b32 s90, s88, 5
    s_add_u32 s89, s89, s90
    s_mov_b32 s92, s30
    s_mov_b32 m0, s92
    s_add_u32 s92, s92, 1024
    s_add_u32 s89, s89, 40960
    s_mov_b32 m0, s92
    s_add_u32 s92, s92, 1024
    s_add_u32 s89, s89, 1269760
    s_mov_b32 m0, s92
    s_add_u32 s92, s92, 1024
    buffer_load_dwordx4 v10, s[60:63], s89 offen  lds
    s_add_u32 s89, s89, 40960
    s_mov_b32 m0, s92
    s_add_u32 s92, s92, 1024
    buffer_load_dwordx4 v10, s[60:63], s89 offen  lds
    v_lshrrev_b32 v12, 1, v22
    v_lshlrev_b32 v12, 4, v12
    v_and_b32 v11, 1, v22
    v_lshl_add_u32 v12, v11, 2, v12
    v_bfe_u32 v11, v0, 2, 1
    v_add_u32 v12, v12, v11
    v_and_b32 v11, 8, v0
    v_add_u32 v12, v12, v11
    v_lshlrev_b32 v12, 5, v12
    v_and_b32 v11, 3, v0
    v_lshl_add_u32 v12, v11, 3, v12
    v_add_u32 v12, s30, v12
    v_and_b32 v13, 7, v0
    s_cmp_lg_u32 s3, 0
    s_cbranch_scc1 L_DN_W
    v_mul_u32_u24 v15, 15360, v13
    v_lshl_add_u32 v15, v22, 4, v15
    s_lshl_b32 s94, s88, 6
    s_add_u32 s93, s94, 78336
    buffer_load_dword v127, v2, s[64:67], 0 offen
L_DN_GB:
    buffer_load_dwordx4 v[24:27], v15, s[52:55], s93 offen sc1
    s_waitcnt vmcnt(0)
    v_xor_b32 v24, s76, v24
    v_xor_b32 v25, s77, v25
    v_xor_b32 v26, s78, v26
    v_xor_b32 v27, s79, v27
    v_or3_b32 v16, v24, v25, v26
    v_or_b32 v16, v16, v27
    v_and_b32 v16, 0xffff, v16
    v_cmp_ne_u32 vcc, 0, v16
    s_sub_u32 s84, s84, 1
    s_cmp_lt_i32 s84, 0
    s_cbranch_scc1 OK_21
    s_cbranch_vccnz L_DN_GB
OK_21:
    v_lshrrev_b32 v15, 1, v13
    v_lshlrev_b32 v15, 14, v15
    v_and_b32 v16, 1, v13
    v_lshl_add_u32 v15, v16, 12, v15
    v_lshl_add_u32 v15, v22, 4, v15
    s_add_u32 s93, s94, s98
    s_add_u32 s93, s93, 1441792
L_DN_X1:
    buffer_load_dwordx4 v[28:31], v15, s[52:55], s93 offen sc1
    s_waitcnt vmcnt(0)
    v_xor_b32 v28, s76, v28
    v_xor_b32 v29, s77, v29
    v_xor_b32 v30, s78, v30
    v_xor_b32 v31, s79, v31
    v_or3_b32 v16, v28, v29, v30
    v_or_b32 v16, v16, v31
    v_and_b32 v16, 0xffff, v16
    v_cmp_ne_u32 vcc, 0, v16
    s_sub_u32 s84, s84, 1
    s_cmp_lt_i32 s84, 0
    s_cbranch_scc1 OK_22
    s_cbranch_vccnz L_DN_X1
OK_22:
    s_cmp_lg_u32 s88, 0
    s_cbranch_scc1 L_DN_END
    s_mov_b64 exec, 1
    v_mov_b32 v124, s10
    v_mov_b32 v125, s11
    v_mov_b32 v126, 0
    buffer_store_dwordx2 v[124:125], v126, s[52:55], 0 offen sc1
    s_mov_b64 exec, -1
L_DN_END:
    v_mul_u32_u24 v15, 1280, v13
    v_lshl_add_u32 v15, v22, 3, v15
L_DN_W:
    s_waitcnt vmcnt(0)
    ds_read_b64_tr_b16 v[96:97], v12 offset:2048
    ds_read_b64_tr_b16 v[98:99], v12 offset:2112
    ds_read_b64_tr_b16 v[100:101], v12 offset:3072
    ds_read_b64_tr_b16 v[102:103], v12 offset:3136
    s_lshl_b32 s93, s3, 11
    s_add_u32 s93, s93, 121856
    v_lshrrev_b32 v19, 1, v22
    v_lshlrev_b32 v19, 4, v19
    v_and_b32 v11, 1, v22
    v_lshl_add_u32 v19, v11, 2, v19
    v_bfe_u32 v11, v0, 2, 1
    v_add_u32 v19, v19, v11
    v_and_b32 v11, 8, v0
    v_add_u32 v19, v19, v11
    v_lshlrev_b32 v19, 5, v19
    v_and_b32 v11, 3, v0
    v_lshl_add_u32 v19, v11, 3, v19
    v_add_u32 v19, s93, v19
    v_lshlrev_b32 v12, 5, v13
    v_lshrrev_b32 v11, 3, v0
    v_lshl_add_u32 v12, v11, 4, v12
    v_lshl_add_u32 v12, v22, 8, v12
    v_lshl_add_u32 v18, v22, 3, v13
    v_lshlrev_b32 v18, 4, v18
    v_lshl_add_u32 v18, v11, 12, v18
    v_lshrrev_b32 v17, 2, v0
    v_lshlrev_b32 v17, 7, v17
    v_and_b32 v11, 1, v22
    v_lshl_add_u32 v17, v11, 6, v17
    v_lshrrev_b32 v11, 1, v22
    v_lshl_add_u32 v17, v11, 5, v17
    v_and_b32 v11, 3, v0
    v_lshl_add_u32 v17, v11, 2, v17
    s_lshl_b32 s93, s3, 9
    v_add_u32 v17, s93, v17
    v_lshrrev_b32 v20, 3, v0
    v_mul_u32_u24 v20, 0xaaaa, v20
    v_add_u32 v20, 0x4444, v20
    v_mov_b32 v72, 0
    v_mov_b32 v73, 0
    v_mov_b32 v74, 0
    v_mov_b32 v75, 0
    s_lshl_b32 s93, s3, 10
    s_and_b32 s94, s93, -8192
    s_add_u32 s93, s93, s94
    s_add_u32 s93, s93, 1703936
    s_add_u32 s93, s93, s98
    s_add_u32 s94, s93, 32768
    s_cmp_ge_u32 s3, 11
    s_cselect_b32 s94, 0x40000000, s94
    s_lshl_b32 s95, s88, 5
    s_waitcnt lgkmcnt(0)
    s_barrier
    ds_read_b64_tr_b16 v[88:89], v19 offset:0
    ds_read_b64_tr_b16 v[90:91], v19 offset:64
    ds_read_b64_tr_b16 v[92:93], v19 offset:1024
    ds_read_b64_tr_b16 v[94:95], v19 offset:1088
    s_waitcnt lgkmcnt(0)
L_DN_POLL:
    buffer_load_dwordx4 v[32:35], v12, s[52:55], s93 offen sc1
    buffer_load_dwordx4 v[36:39], v12, s[52:55], s94 offen sc1
    s_waitcnt vmcnt(0)
    v_max3_u32 v40, v32, v33, v34
    v_max3_u32 v41, v35, v36, v37
    v_max3_u32 v40, v40, v38, v39
    v_max_u32 v40, v40, v41
    v_cmp_eq_u32 vcc, -1, v40
    s_cbranch_vccz L_DN_POLL_D0
    s_sub_u32 s84, s84, 1
    s_cmp_lt_i32 s84, 0
    s_cbranch_scc0 L_DN_POLL
L_DN_POLL_D0:
    v_smfmac_f32_16x16x64_bf16 v[72:75], v[32:35], v[88:95], v20
    v_smfmac_f32_16x16x64_bf16 v[72:75], v[36:39], v[96:103], v20
L_DN_POLL_OK:
    s_nop 7
    v_permlane32_swap_b32 v72, v74
    v_permlane32_swap_b32 v73, v75
    v_pk_add_f32 v[72:73], v[72:73], v[74:75]
    ds_write2_b32 v17, v72, v73 offset0:0 offset1:4
    s_waitcnt lgkmcnt(0)
    s_barrier
    s_cmp_lg_u32 s3, 0
    s_cbranch_scc1 L_END
    ds_read_b128 v[40:43], v18 offset:0
    ds_read_b128 v[44:47], v18 offset:512
    ds_read_b128 v[48:51], v18 offset:1024
    ds_read_b128 v[52:55], v18 offset:1536
    ds_read_b128 v[56:59], v18 offset:2048
    ds_read_b128 v[60:63], v18 offset:2560
    ds_read_b128 v[64:67], v18 offset:3072
    ds_read_b128 v[68:71], v18 offset:3584
    s_waitcnt lgkmcnt(6)
    v_pk_add_f32 v[40:41], v[40:41], v[44:45]
    v_pk_add_f32 v[42:43], v[42:43], v[46:47]
    s_waitcnt lgkmcnt(5)
    v_pk_add_f32 v[40:41], v[40:41], v[48:49]
    v_pk_add_f32 v[42:43], v[42:43], v[50:51]
    s_waitcnt lgkmcnt(4)
    v_pk_add_f32 v[40:41], v[40:41], v[52:53]
    v_pk_add_f32 v[42:43], v[42:43], v[54:55]
    s_waitcnt lgkmcnt(3)
    v_pk_add_f32 v[40:41], v[40:41], v[56:57]
    v_pk_add_f32 v[42:43], v[42:43], v[58:59]
    s_waitcnt lgkmcnt(2)
    v_pk_add_f32 v[40:41], v[40:41], v[60:61]
    v_pk_add_f32 v[42:43], v[42:43], v[62:63]
    s_waitcnt lgkmcnt(1)
    v_pk_add_f32 v[40:41], v[40:41], v[64:65]
    v_pk_add_f32 v[42:43], v[42:43], v[66:67]
    s_waitcnt lgkmcnt(0)
    v_pk_add_f32 v[40:41], v[40:41], v[68:69]
    v_pk_add_f32 v[42:43], v[42:43], v[70:71]
    s_nop 0
    v_add_f32_dpp v40, v40, v40 row_ror:8 row_mask:0xf bank_mask:0xf
    v_add_f32_dpp v41, v41, v41 row_ror:8 row_mask:0xf bank_mask:0xf
    v_add_f32_dpp v42, v42, v42 row_ror:8 row_mask:0xf bank_mask:0xf
    v_add_f32_dpp v43, v43, v43 row_ror:8 row_mask:0xf bank_mask:0xf
    v_pk_fma_f32 v[40:41], v[40:41], v[24:25], v[28:29]
    v_pk_fma_f32 v[42:43], v[42:43], v[26:27], v[30:31]
    v_cvt_pk_bf16_f32 v44, v40, v41
    v_cvt_pk_bf16_f32 v45, v42, v43
    s_mov_b32 exec_lo, 0x00ff00ff
    s_mov_b32 exec_hi, 0x00ff00ff
    buffer_store_dwordx2 v[44:45], v15, s[64:67], s95 offen
    s_mov_b64 exec, -1
    s_endpgm
L_HELPER:
    s_sub_u32 s91, s3, 0
    s_setprio 3
    s_cmp_lg_u32 s91, 0
    s_cbranch_scc1 L_NOINIT
    v_mov_b32 v16, 0
    v_mov_b32 v17, 0xff800000
    v_mov_b32 v18, 0
    v_mov_b32 v19, 0
    ds_write_b128 v16, v[16:19] offset:11584
    ds_write_b64 v16, v[18:19] offset:11600
    ds_write_b64 v16, v[18:19] offset:11608
L_NOINIT:
    v_lshrrev_b32 v11, 2, v1
    v_mul_u32_u24 v11, 7680, v11
    v_and_b32 v12, 3, v1
    v_lshl_add_u32 v11, v12, 4, v11
    v_and_b32 v15, 7, v1
    v_mul_u32_u24 v12, 1280, v15
    v_lshrrev_b32 v8, 3, v0
    v_lshl_add_u32 v12, v8, 6, v12
    v_lshl_add_u32 v12, v22, 4, v12
    s_sub_u32 s86, s7, 8
    s_cmp_lt_u32 s7, 16
    s_cselect_b32 s86, 99, s86
    s_cmp_lt_u32 s7, 8
    s_cselect_b32 s86, s7, s86
    s_lshr_b32 s89, s86, 1
    s_add_u32 s16, s89, s6
    s_and_b32 s16, s16, 7
    s_lshl_b32 s89, s89, 3
    s_add_u32 s89, s89, s16
    s_lshl_b32 s89, s89, 1
    s_and_b32 s16, s86, 1
    s_add_u32 s89, s89, s16
    s_add_u32 s16, s6, 112
    s_cmp_eq_u32 s86, 14
    s_cselect_b32 s89, s16, s89
    s_mul_i32 s92, s91, 10240
    s_add_u32 s92, s92, 121856
    s_mul_i32 s16, s91, 1228800
    s_mul_i32 s17, s89, 64
    s_add_u32 s16, s16, s17
    s_mul_i32 s18, s91, 320
    s_waitcnt lgkmcnt(0)
    s_load_dwordx2 s[10:11], s[8:9], 0
    s_barrier
    s_mov_b32 s68, s40
    s_and_b32 s69, s41, 0xffff
    s_mov_b32 s70, 0x4b0000
    s_mov_b32 s71, 0x20000
    s_cmp_ge_u32 s86, 15
    s_cbranch_scc1 L_H_NOM
    s_mov_b32 s64, s38
    s_and_b32 s65, s39, 0xffff
    s_mov_b32 s66, 0x2800
    s_mov_b32 s67, 0x20000
    buffer_load_dwordx4 v[24:27], v12, s[64:67], s18 offen offset:0
    buffer_load_dwordx4 v[28:31], v12, s[64:67], s18 offen offset:128
    buffer_load_dwordx4 v[32:35], v12, s[64:67], s18 offen offset:256
    s_mov_b32 s17, s92
    s_mov_b32 m0, s17
    s_add_u32 s17, s17, 1024
    buffer_load_dwordx4 v11, s[68:71], s16 offen  lds
    s_add_u32 s16, s16, 122880
    s_mov_b32 m0, s17
    s_add_u32 s17, s17, 1024
    buffer_load_dwordx4 v11, s[68:71], s16 offen  lds
    s_add_u32 s16, s16, 122880
    s_mov_b32 m0, s17
    s_add_u32 s17, s17, 1024
    buffer_load_dwordx4 v11, s[68:71], s16 offen  lds
    s_add_u32 s16, s16, 122880
    s_mov_b32 m0, s17
    s_add_u32 s17, s17, 1024
    buffer_load_dwordx4 v11, s[68:71], s16 offen  lds
    s_add_u32 s16, s16, 122880
    s_mov_b32 m0, s17
    s_add_u32 s17, s17, 1024
    buffer_load_dwordx4 v11, s[68:71], s16 offen  lds
    s_add_u32 s16, s16, 122880
    s_mov_b32 m0, s17
    s_add_u32 s17, s17, 1024
    buffer_load_dwordx4 v11, s[68:71], s16 offen  lds
    s_add_u32 s16, s16, 122880
    s_mov_b32 m0, s17
    s_add_u32 s17, s17, 1024
    buffer_load_dwordx4 v11, s[68:71], s16 offen  lds
    s_add_u32 s16, s16, 122880
    s_mov_b32 m0, s17
    s_add_u32 s17, s17, 1024
    buffer_load_dwordx4 v11, s[68:71], s16 offen  lds
    s_add_u32 s16, s16, 122880
    s_mov_b32 m0, s17
    s_add_u32 s17, s17, 1024
    buffer_load_dwordx4 v11, s[68:71], s16 offen  lds
    s_add_u32 s16, s16, 122880
    s_mov_b32 m0, s17
    s_add_u32 s17, s17, 1024
    buffer_load_dwordx4 v11, s[68:71], s16 offen  lds
    s_add_u32 s16, s16, 122880
L_H_NOM:
    v_and_b32 v8, 1, v0
    v_lshlrev_b32 v8, 4, v8
    v_mov_b32 v9, 0xffff
    v_lshlrev_b32 v9, v8, v9
    v_bfe_u32 v8, v0, 1, 2
    v_cmp_eq_u32 vcc, 0, v8
    s_nop 1
    v_cndmask_b32 v3, 0, v9, vcc
    v_cmp_eq_u32 vcc, 1, v8
    s_nop 1
    v_cndmask_b32 v4, 0, v9, vcc
    v_cmp_eq_u32 vcc, 2, v8
    s_nop 1
    v_cndmask_b32 v5, 0, v9, vcc
    v_cmp_eq_u32 vcc, 3, v8
    s_nop 1
    v_cndmask_b32 v6, 0, v9, vcc
    s_mov_b32 s52, s8
    s_and_b32 s53, s9, 0xffff
    s_mov_b32 s54, 0x1e0000
    s_mov_b32 s55, 0x20000
    s_mov_b32 s84, 2097152
    s_waitcnt lgkmcnt(0)
    s_add_u32 s10, s10, 0x00010001
    s_addc_u32 s11, s11, 0x00010001
    s_and_b32 s76, s10, 0xffff
    s_lshr_b32 s77, s10, 16
    s_and_b32 s78, s11, 0xffff
    s_lshr_b32 s79, s11, 16
    s_and_b32 s80, s76, 0xf
    s_and_b32 s81, s77, 0xf
    s_and_b32 s82, s78, 0xf
    s_and_b32 s83, s79, 0xf
    v_mov_b32 v7, s10
    v_mov_b32 v10, s11
    v_cmp_lt_u32 vcc, 1, v22
    s_nop 1
    v_cndmask_b32 v7, v7, v10, vcc
    v_and_b32 v10, 1, v22
    v_lshlrev_b32 v10, 4, v10
    v_lshrrev_b32 v7, v10, v7
    v_and_b32 v7, 0xffff, v7
    s_cmp_ge_u32 s86, 15
    s_cbranch_scc1 L_MDONE
    v_lshrrev_b32 v16, 2, v0
    v_lshl_add_u32 v16, v22, 3, v16
    v_lshlrev_b32 v16, 6, v16
    v_and_b32 v18, 3, v0
    v_lshl_add_u32 v16, v18, 3, v16
    v_add_u32 v16, s92, v16
    v_add_u32 v17, s92, v2
    s_waitcnt vmcnt(10)
    v_lshlrev_b32 v18, 16, v24
    v_and_b32 v19, 0xffff0000, v24
    v_mul_f32 v20, 0xbfb8aa3b, v18
    v_mul_f32 v21, 0xbfb8aa3b, v19
    v_exp_f32 v20, v20
    v_exp_f32 v21, v21
    s_nop 0
    v_add_f32 v20, 1.0, v20
    v_add_f32 v21, 1.0, v21
    v_rcp_f32 v20, v20
    v_rcp_f32 v21, v21
    s_nop 0
    v_mul_f32 v18, v18, v20
    v_mul_f32 v19, v19, v21
    v_cvt_pk_bf16_f32 v24, v18, v19
    v_lshlrev_b32 v18, 16, v25
    v_and_b32 v19, 0xffff0000, v25
    v_mul_f32 v20, 0xbfb8aa3b, v18
    v_mul_f32 v21, 0xbfb8aa3b, v19
    v_exp_f32 v20, v20
    v_exp_f32 v21, v21
    s_nop 0
    v_add_f32 v20, 1.0, v20
    v_add_f32 v21, 1.0, v21
    v_rcp_f32 v20, v20
    v_rcp_f32 v21, v21
    s_nop 0
    v_mul_f32 v18, v18, v20
    v_mul_f32 v19, v19, v21
    v_cvt_pk_bf16_f32 v25, v18, v19
    v_lshlrev_b32 v18, 16, v26
    v_and_b32 v19, 0xffff0000, v26
    v_mul_f32 v20, 0xbfb8aa3b, v18
    v_mul_f32 v21, 0xbfb8aa3b, v19
    v_exp_f32 v20, v20
    v_exp_f32 v21, v21
    s_nop 0
    v_add_f32 v20, 1.0, v20
    v_add_f32 v21, 1.0, v21
    v_rcp_f32 v20, v20
    v_rcp_f32 v21, v21
    s_nop 0
    v_mul_f32 v18, v18, v20
    v_mul_f32 v19, v19, v21
    v_cvt_pk_bf16_f32 v26, v18, v19
    v_lshlrev_b32 v18, 16, v27
    v_and_b32 v19, 0xffff0000, v27
    v_mul_f32 v20, 0xbfb8aa3b, v18
    v_mul_f32 v21, 0xbfb8aa3b, v19
    v_exp_f32 v20, v20
    v_exp_f32 v21, v21
    s_nop 0
    v_add_f32 v20, 1.0, v20
    v_add_f32 v21, 1.0, v21
    v_rcp_f32 v20, v20
    v_rcp_f32 v21, v21
    s_nop 0
    v_mul_f32 v18, v18, v20
    v_mul_f32 v19, v19, v21
    v_cvt_pk_bf16_f32 v27, v18, v19
    v_lshlrev_b32 v18, 16, v28
    v_and_b32 v19, 0xffff0000, v28
    v_mul_f32 v20, 0xbfb8aa3b, v18
    v_mul_f32 v21, 0xbfb8aa3b, v19
    v_exp_f32 v20, v20
    v_exp_f32 v21, v21
    s_nop 0
    v_add_f32 v20, 1.0, v20
    v_add_f32 v21, 1.0, v21
    v_rcp_f32 v20, v20
    v_rcp_f32 v21, v21
    s_nop 0
    v_mul_f32 v18, v18, v20
    v_mul_f32 v19, v19, v21
    v_cvt_pk_bf16_f32 v28, v18, v19
    v_lshlrev_b32 v18, 16, v29
    v_and_b32 v19, 0xffff0000, v29
    v_mul_f32 v20, 0xbfb8aa3b, v18
    v_mul_f32 v21, 0xbfb8aa3b, v19
    v_exp_f32 v20, v20
    v_exp_f32 v21, v21
    s_nop 0
    v_add_f32 v20, 1.0, v20
    v_add_f32 v21, 1.0, v21
    v_rcp_f32 v20, v20
    v_rcp_f32 v21, v21
    s_nop 0
    v_mul_f32 v18, v18, v20
    v_mul_f32 v19, v19, v21
    v_cvt_pk_bf16_f32 v29, v18, v19
    v_lshlrev_b32 v18, 16, v30
    v_and_b32 v19, 0xffff0000, v30
    v_mul_f32 v20, 0xbfb8aa3b, v18
    v_mul_f32 v21, 0xbfb8aa3b, v19
    v_exp_f32 v20, v20
    v_exp_f32 v21, v21
    s_nop 0
    v_add_f32 v20, 1.0, v20
    v_add_f32 v21, 1.0, v21
    v_rcp_f32 v20, v20
    v_rcp_f32 v21, v21
    s_nop 0
    v_mul_f32 v18, v18, v20
    v_mul_f32 v19, v19, v21
    v_cvt_pk_bf16_f32 v30, v18, v19
    v_lshlrev_b32 v18, 16, v31
    v_and_b32 v19, 0xffff0000, v31
    v_mul_f32 v20, 0xbfb8aa3b, v18
    v_mul_f32 v21, 0xbfb8aa3b, v19
    v_exp_f32 v20, v20
    v_exp_f32 v21, v21
    s_nop 0
    v_add_f32 v20, 1.0, v20
    v_add_f32 v21, 1.0, v21
    v_rcp_f32 v20, v20
    v_rcp_f32 v21, v21
    s_nop 0
    v_mul_f32 v18, v18, v20
    v_mul_f32 v19, v19, v21
    v_cvt_pk_bf16_f32 v31, v18, v19
    v_lshlrev_b32 v18, 16, v32
    v_and_b32 v19, 0xffff0000, v32
    v_mul_f32 v20, 0xbfb8aa3b, v18
    v_mul_f32 v21, 0xbfb8aa3b, v19
    v_exp_f32 v20, v20
    v_exp_f32 v21, v21
    s_nop 0
    v_add_f32 v20, 1.0, v20
    v_add_f32 v21, 1.0, v21
    v_rcp_f32 v20, v20
    v_rcp_f32 v21, v21
    s_nop 0
    v_mul_f32 v18, v18, v20
    v_mul_f32 v19, v19, v21
    v_cvt_pk_bf16_f32 v32, v18, v19
    v_lshlrev_b32 v18, 16, v33
    v_and_b32 v19, 0xffff0000, v33
    v_mul_f32 v20, 0xbfb8aa3b, v18
    v_mul_f32 v21, 0xbfb8aa3b, v19
    v_exp_f32 v20, v20
    v_exp_f32 v21, v21
    s_nop 0
    v_add_f32 v20, 1.0, v20
    v_add_f32 v21, 1.0, v21
    v_rcp_f32 v20, v20
    v_rcp_f32 v21, v21
    s_nop 0
    v_mul_f32 v18, v18, v20
    v_mul_f32 v19, v19, v21
    v_cvt_pk_bf16_f32 v33, v18, v19
    v_lshlrev_b32 v18, 16, v34
    v_and_b32 v19, 0xffff0000, v34
    v_mul_f32 v20, 0xbfb8aa3b, v18
    v_mul_f32 v21, 0xbfb8aa3b, v19
    v_exp_f32 v20, v20
    v_exp_f32 v21, v21
    s_nop 0
    v_add_f32 v20, 1.0, v20
    v_add_f32 v21, 1.0, v21
    v_rcp_f32 v20, v20
    v_rcp_f32 v21, v21
    s_nop 0
    v_mul_f32 v18, v18, v20
    v_mul_f32 v19, v19, v21
    v_cvt_pk_bf16_f32 v34, v18, v19
    v_lshlrev_b32 v18, 16, v35
    v_and_b32 v19, 0xffff0000, v35
    v_mul_f32 v20, 0xbfb8aa3b, v18
    v_mul_f32 v21, 0xbfb8aa3b, v19
    v_exp_f32 v20, v20
    v_exp_f32 v21, v21
    s_nop 0
    v_add_f32 v20, 1.0, v20
    v_add_f32 v21, 1.0, v21
    v_rcp_f32 v20, v20
    v_rcp_f32 v21, v21
    s_nop 0
    v_mul_f32 v18, v18, v20
    v_mul_f32 v19, v19, v21
    v_cvt_pk_bf16_f32 v35, v18, v19
    s_waitcnt vmcnt(0) lgkmcnt(0)
    ds_read_b64_tr_b16 v[36:37], v16 offset:0
    ds_read_b64_tr_b16 v[38:39], v16 offset:256
    ds_read_b64_tr_b16 v[40:41], v16 offset:2048
    ds_read_b64_tr_b16 v[42:43], v16 offset:2304
    ds_read_b64_tr_b16 v[44:45], v16 offset:4096
    ds_read_b64_tr_b16 v[46:47], v16 offset:4352
    ds_read_b64_tr_b16 v[48:49], v16 offset:6144
    ds_read_b64_tr_b16 v[50:51], v16 offset:6400
    ds_read_b64_tr_b16 v[52:53], v16 offset:8192
    ds_read_b64_tr_b16 v[54:55], v16 offset:8448
    s_waitcnt lgkmcnt(0)
    ds_read_b64_tr_b16 v[56:57], v16 offset:32
    ds_read_b64_tr_b16 v[58:59], v16 offset:288
    ds_read_b64_tr_b16 v[60:61], v16 offset:2080
    ds_read_b64_tr_b16 v[62:63], v16 offset:2336
    ds_read_b64_tr_b16 v[64:65], v16 offset:4128
    ds_read_b64_tr_b16 v[66:67], v16 offset:4384
    ds_read_b64_tr_b16 v[68:69], v16 offset:6176
    ds_read_b64_tr_b16 v[70:71], v16 offset:6432
    ds_read_b64_tr_b16 v[72:73], v16 offset:8224
    ds_read_b64_tr_b16 v[74:75], v16 offset:8480
    v_mfma_f32_16x16x32_bf16 v[76:79], v[36:39], v[24:27], 0
    v_mfma_f32_16x16x32_bf16 v[80:83], v[40:43], v[24:27], 0
    v_mfma_f32_16x16x32_bf16 v[76:79], v[44:47], v[28:31], v[76:79]
    v_mfma_f32_16x16x32_bf16 v[80:83], v[48:51], v[28:31], v[80:83]
    v_mfma_f32_16x16x32_bf16 v[76:79], v[52:55], v[32:35], v[76:79]
    s_waitcnt lgkmcnt(0)
    v_mfma_f32_16x16x32_bf16 v[84:87], v[56:59], v[24:27], 0
    v_mfma_f32_16x16x32_bf16 v[88:91], v[60:63], v[24:27], 0
    v_mfma_f32_16x16x32_bf16 v[84:87], v[64:67], v[28:31], v[84:87]
    v_mfma_f32_16x16x32_bf16 v[88:91], v[68:71], v[28:31], v[88:91]
    v_mfma_f32_16x16x32_bf16 v[84:87], v[72:75], v[32:35], v[84:87]
    s_nop 7
    v_add_f32_dpp v108, v80, v76 row_ror:8 row_mask:0xf bank_mask:0x3
    v_add_f32_dpp v109, v81, v77 row_ror:8 row_mask:0xf bank_mask:0x3
    v_add_f32_dpp v110, v82, v78 row_ror:8 row_mask:0xf bank_mask:0x3
    v_add_f32_dpp v111, v83, v79 row_ror:8 row_mask:0xf bank_mask:0x3
    v_add_f32_dpp v108, v84, v88 row_ror:8 row_mask:0xf bank_mask:0xc
    v_add_f32_dpp v109, v85, v89 row_ror:8 row_mask:0xf bank_mask:0xc
    v_add_f32_dpp v110, v86, v90 row_ror:8 row_mask:0xf bank_mask:0xc
    v_add_f32_dpp v111, v87, v91 row_ror:8 row_mask:0xf bank_mask:0xc
    ds_write_b128 v17, v[108:111] offset:0
    v_mov_b32 v18, 0
    v_mov_b32 v19, 1
    s_waitcnt lgkmcnt(0)
    s_mov_b64 exec, 1
    ds_add_rtn_u32 v19, v18, v19 offset:11584
    s_mov_b64 exec, -1
    s_waitcnt lgkmcnt(0)
    v_readfirstlane_b32 s16, v19
    s_nop 3
    s_cmp_lg_u32 s16, 3
    s_cbranch_scc1 L_MDONE
    v_add_u32 v17, 121856, v2
    ds_read_b128 v[88:91], v17 offset:0
    ds_read_b128 v[92:95], v17 offset:10240
    ds_read_b128 v[96:99], v17 offset:20480
    ds_read_b128 v[100:103], v17 offset:30720
    v_mul_u32_u24 v16, 15360, v15
    v_lshl_add_u32 v16, v22, 4, v16
    v_lshrrev_b32 v18, 3, v0
    v_lshl_add_u32 v16, v18, 6, v16
    s_mul_i32 s16, s89, 128
    s_add_u32 s16, s16, 65536
    s_waitcnt lgkmcnt(2)
    v_add_f32 v88, v88, v92
    v_add_f32 v89, v89, v93
    v_add_f32 v90, v90, v94
    v_add_f32 v91, v91, v95
    s_waitcnt lgkmcnt(1)
    v_add_f32 v88, v88, v96
    v_add_f32 v89, v89, v97
    v_add_f32 v90, v90, v98
    v_add_f32 v91, v91, v99
    s_waitcnt lgkmcnt(0)
    v_add_f32 v88, v88, v100
    v_add_f32 v89, v89, v101
    v_add_f32 v90, v90, v102
    v_add_f32 v91, v91, v103
    v_cvt_pk_bf16_f32 v89, v88, v89
    v_cvt_pk_bf16_f32 v91, v90, v91
    v_lshlrev_b32 v88, 16, v89
    v_and_b32 v89, 0xffff0000, v89
    v_lshlrev_b32 v90, 16, v91
    v_and_b32 v91, 0xffff0000, v91
    v_or_b32 v88, s76, v88
    v_or_b32 v89, s77, v89
    v_or_b32 v90, s78, v90
    v_or_b32 v91, s79, v91
    buffer_store_dwordx4 v[88:91], v16, s[52:55], s16 offen offset:0 sc1
    s_mov_b64 exec, -1
L_MDONE:
    s_mov_b32 s87, 1
    s_mul_i32 s88, s6, 10
    s_add_u32 s88, s88, s7
    s_cmp_lt_u32 s7, 10
    s_cbranch_scc1 RID_23
    s_mov_b32 s87, 3
    s_mul_i32 s88, s6, 5
    s_add_u32 s88, s88, s7
    s_sub_u32 s88, s88, 10
    s_sub_u32 s16, s7, 10
    s_cmp_lt_u32 s16, 5
    s_cbranch_scc1 RID_23
    s_mov_b32 s87, 0
    s_cmp_lt_u32 s7, 23
    s_cbranch_scc1 RID_23
    s_cmp_ge_u32 s7, 30
    s_cbranch_scc1 RID_23
    s_mul_i32 s88, s6, 7
    s_add_u32 s88, s88, s7
    s_sub_u32 s88, s88, 23
    s_cmp_lt_u32 s88, 54
    s_cselect_b32 s87, 2, 0
RID_23:
    s_cmp_lg_u32 s87, 2
    s_cbranch_scc1 L_HRET
    s_cmp_gt_u32 s91, 1
    s_cbranch_scc1 L_HRET
    s_lshl_b32 s16, s88, 1
    s_add_u32 s16, s16, s91
    s_lshl_b32 s16, s16, 8
    s_and_b32 s17, s16, -8192
    s_add_u32 s16, s16, s17
    s_add_u32 s16, s16, 1703936
    v_mov_b32 v126, -1
    buffer_store_dword v126, v14, s[52:55], s16 offen sc1
    s_add_u32 s16, s16, 0x2000
    buffer_store_dword v126, v14, s[52:55], s16 offen sc1
    s_add_u32 s16, s16, 0xe000
    buffer_store_dword v126, v14, s[52:55], s16 offen sc1
    s_add_u32 s16, s16, 0x2000
    buffer_store_dword v126, v14, s[52:55], s16 offen sc1
L_HRET:
    s_mov_b32 s99, 0
    s_branch L_PH1
L_CAL:
    s_mov_b32 s60, -1
    s_mov_b32 s61, -1
    s_mov_b32 s62, 8
L_CAL1:
    s_memtime s[64:65]
    s_waitcnt lgkmcnt(0)
    s_load_dword s63, s[8:9], 16384 glc
    s_waitcnt lgkmcnt(0)
    s_memtime s[66:67]
    s_waitcnt lgkmcnt(0)
    s_load_dword s63, s[8:9], 24576 glc
    s_waitcnt lgkmcnt(0)
    s_memtime s[68:69]
    s_waitcnt lgkmcnt(0)
    s_sub_u32 s68, s68, s66
    s_sub_u32 s66, s66, s64
    s_min_u32 s60, s60, s66
    s_min_u32 s61, s61, s68
    s_sub_u32 s62, s62, 1
    s_cmp_lg_u32 s62, 0
    s_cbranch_scc1 L_CAL1
    s_cmp_lt_u32 s61, s60
    s_cselect_b32 s62, 1, 0
    s_add_u32 s63, s10, 0x00010001
    s_xor_b32 s63, s63, s62
    s_mov_b32 s52, s8
    s_and_b32 s53, s9, 0xffff
    s_mov_b32 s54, 0x1e0000
    s_mov_b32 s55, 0x20000
    v_mov_b32 v8, s63
    v_mov_b32 v9, 4096
    s_mov_b64 exec, 1
    buffer_store_dword v8, v9, s[52:55], 0 offen sc1
    s_mov_b64 exec, -1
    s_branch L_NOCAL
L_END:
    s_endpgm
.section .rodata,"a"
.p2align 6
.amdhsa_kernel adaLN_cond__sliding_block_cached__glu_gated_reglu__decode_kernel
  .amdhsa_next_free_vgpr 128
  .amdhsa_next_free_sgpr 102
  .amdhsa_accum_offset 128
  .amdhsa_group_segment_fixed_size 0
  .amdhsa_kernarg_size 112
  .amdhsa_user_sgpr_count 2
  .amdhsa_user_sgpr_kernarg_segment_ptr 1
  .amdhsa_system_sgpr_workgroup_id_x 1
  .amdhsa_float_denorm_mode_32 3
.end_amdhsa_kernel
```
